```python
import torch

def _softmax(x, axis=-1):
    return torch.softmax(x, dim=axis)
def _gelu(x):
    return torch.nn.functional.gelu(x, approximate="tanh")
def _silu(x):
    return torch.nn.functional.silu(x)
def _sigmoid(x):
    return torch.sigmoid(x)
def _layernorm(x, axis=-1, eps=1e-5):
    m = x.mean(dim=axis, keepdim=True)
    v = x.var(dim=axis, keepdim=True, unbiased=False)
    return (x - m) / torch.sqrt(v + eps)
def _scatter_add(tgt, idx, src, axis=0):
    return tgt.clone().index_add_(axis, idx, src)
def _segment_sum(src, seg, n):
    out = torch.zeros((n,) + src.shape[1:], dtype=src.dtype)
    return out.index_add_(0, seg, src)
def _pad(x, pw):
    flat = tuple(v for pair in reversed(pw) for v in pair)
    return torch.nn.functional.pad(x, flat)

kernel_name = 'parallel_sum__spectral_gfnet__glu_gated_swiglu__prompt'

def setup_inputs():

    _w = (lambda a: (lambda t: t.to(torch.bfloat16) if t.is_floating_point() else t)(torch.as_tensor(a)))
    def _A_setup():
        B, S, D = 1, 2048, 640
        Df = D // 2 + 1
        return {
            "x": _w((lambda *s: torch.randn(*s, dtype=torch.bfloat16) * 0.05)(B, S, D)),
            "w_r": _w((lambda *s: torch.randn(*s, dtype=torch.bfloat16) * 0.4)(S, Df) * 0.02),
            "w_i": _w((lambda *s: torch.randn(*s, dtype=torch.bfloat16) * 0.4)(S, Df) * 0.02),
        }
    _A_in = _A_setup()

    def _B_setup():
        B, S, D, F = 1, 2048, 640, 1536
        return {
            "x": _w((lambda *s: torch.randn(*s, dtype=torch.bfloat16) * 0.05)(B, S, D)),
            "w1": _w((lambda *s: torch.randn(*s, dtype=torch.bfloat16) * 0.2)(D, F) * (2.0 / D) ** 0.5),
            "w3": _w((lambda *s: torch.randn(*s, dtype=torch.bfloat16) * 0.2)(D, F) * (2.0 / D) ** 0.5),
            "w2": _w((lambda *s: torch.randn(*s, dtype=torch.bfloat16) * 0.2)(F, D) * (2.0 / F) ** 0.5),
        }
    _B_in = _B_setup()

    return {
        "A_x": _A_in["x"],
        "A_w_r": _A_in["w_r"],
        "A_w_i": _A_in["w_i"],
        "B_x": _B_in["x"],
        "B_w1": _B_in["w1"],
        "B_w3": _B_in["w3"],
        "B_w2": _B_in["w2"],
    }

def reference(A_x, A_w_r, A_w_i, B_x, B_w1, B_w3, B_w2):
    def _A_ref(x, w_r, w_i):
        B, S, D = x.shape
        X = (lambda x, axes=(-2,-1): torch.fft.rfft2(x.float(), dim=axes))(x, axes=(-2, -1))
        W = w_r + 1j * w_i
        X = X * W
        y = (lambda x, s, axes=(-2,-1): torch.fft.irfft2(x, s=s, dim=axes).to(torch.bfloat16))(X, (S, D), axes=(-2, -1))
        return y

    def _B_ref(x, w1, w3, w2):
        gate = torch.einsum("bsd,df->bsf", x, w1)
        up = torch.einsum("bsd,df->bsf", x, w3)
        h = _silu(gate) * up
        out = torch.einsum("bsf,fd->bsd", h, w2)
        return out

    x = A_x
    xn = _layernorm(x, axis=-1)
    return x + _A_ref(xn, A_w_r, A_w_i) + _B_ref(xn, B_w1, B_w3, B_w2)
```

```asm
; @launch grid=(256,1,1) block=(768,1,1) lds=163840
.amdgcn_target "amdgcn-amd-amdhsa--gfx950"
.text
.globl parallel_sum__spectral_gfnet__glu_gated_swiglu__prompt_kernel
.p2align 8
.type parallel_sum__spectral_gfnet__glu_gated_swiglu__prompt_kernel,@function
parallel_sum__spectral_gfnet__glu_gated_swiglu__prompt_kernel:
    s_cmp_ge_u32 s2, 256
    s_cbranch_scc1 k_end
    v_lshrrev_b32 v1, 6, v0
    v_and_b32 v0, 63, v0
    v_readfirstlane_b32 s3, v1
    v_mov_b32 v1, 122880
    v_mov_b32 v4, 0
    v_mov_b32 v5, 0
    s_cmp_lg_u32 s3, 0
    s_cbranch_scc1 k_noinit
    s_cmp_ge_u32 s2, 128
    s_cbranch_scc1 k_nocpf
    s_getpc_b64 s[56:57]
k_pcref:
    s_sub_u32 s56, s56, k_pcref-parallel_sum__spectral_gfnet__glu_gated_swiglu__prompt_kernel
    s_subb_u32 s57, s57, 0
    s_mov_b32 s58, k_tend-parallel_sum__spectral_gfnet__glu_gated_swiglu__prompt_kernel
    s_mov_b32 s59, 0x20000
    s_lshr_b32 s37, s2, 3
    s_mul_i32 s37, s37, 2560
    v_lshlrev_b32 v3, 7, v0
    s_mov_b64 exec, 1048575
    buffer_load_dword v11, v3, s[56:59], s37 offen
    s_mov_b64 exec, -1
k_nocpf:
    v_lshl_add_u32 v3, v0, 3, v1
    ds_write_b64 v3, v[4:5]
    s_waitcnt lgkmcnt(0)
k_noinit:
    s_load_dwordx16 s[64:79], s[0:1], 0
    s_load_dwordx4 s[80:83], s[0:1], 64
    s_and_b32 s30, s2, 7
    s_lshr_b32 s31, s2, 3
    s_lshr_b32 s37, s30, 2
    s_lshl_b32 s37, s37, 3
    s_and_b32 s32, s31, 7
    s_add_u32 s32, s32, s37
    s_and_b32 s37, s30, 3
    s_lshl_b32 s37, s37, 2
    s_lshr_b32 s38, s31, 3
    s_add_u32 s33, s38, s37
    s_lshl_b32 s34, s30, 5
    s_add_u32 s34, s34, s31
    s_lshr_b32 s28, s30, 1
    s_lshl_b32 s28, s28, 2
    s_add_u32 s28, s28, s38
    s_bfe_u32 s29, s31, 0x10002
    s_and_b32 s36, s30, 1
    s_lshl_b32 s36, s36, 2
    s_and_b32 s37, s31, 3
    s_add_u32 s36, s36, s37
    s_mov_b32 s35, 0
    v_mov_b32 v2, 1
    s_barrier
    s_cmp_lt_u32 s3, 4
    s_cbranch_scc1 k_G
    s_cmp_ge_u32 s3, 8
    s_cbranch_scc1 k_Sr
    s_setprio 2
    s_sub_u32 s41, s3, 4
    s_lshl_b32 s42, s41, 12
    s_lshl_b32 s43, s41, 11
    s_add_u32 s43, s43, 49152
    s_lshl_b32 s44, s41, 10
    s_add_u32 s44, s44, 98304
    v_lshrrev_b32 v12, 3, v0
    s_lshl_b32 s37, s32, 4
    s_lshl_b32 s38, s41, 9
    s_add_u32 s37, s37, s38
    v_add_u32 v13, s37, v12
    v_mul_u32_u24 v13, 1280, v13
    v_lshrrev_b32 v14, 4, v0
    v_and_b32 v15, 7, v0
    v_xor_b32 v16, v15, v14
    v_xor_b32 v17, 4, v16
    v_lshl_add_u32 v4, v16, 4, v13
    v_lshl_add_u32 v5, v17, 4, v13
    v_add_u32 v5, 10240, v5
    v_add_u32 v6, 327680, v4
    v_add_u32 v7, 327680, v5
    s_lshl_b32 s38, s41, 4
    v_add_u32 v13, s38, v12
    v_mul_u32_u24 v13, 3072, v13
    v_bfe_u32 v14, v0, 4, 1
    v_lshlrev_b32 v14, 2, v14
    v_xor_b32 v14, v14, v15
    v_lshl_add_u32 v13, v14, 4, v13
    s_and_b32 s39, s33, 1
    s_lshl_b32 s37, s39, 6
    s_mul_i32 s40, s33, 192
    s_add_u32 s37, s37, s40
    v_add_u32 v8, s37, v13
    v_add_u32 v9, 24576, v8
    v_lshrrev_b32 v13, 2, v0
    v_add_u32 v13, s38, v13
    v_mul_u32_u24 v13, 3072, v13
    s_xor_b32 s39, s39, 1
    s_lshl_b32 s39, s39, 7
    s_add_u32 s39, s39, s40
    v_add_u32 v13, s39, v13
    v_and_b32 v14, 3, v0
    v_lshl_add_u32 v10, v14, 4, v13
    v_xor_b32 v14, 2, v14
    v_lshl_add_u32 v11, v14, 4, v13
    s_cmp_ge_u32 s32, 10
    s_cselect_b32 s37, 10, 0
    s_cselect_b32 s51, 0, 1
    s_sub_u32 s50, s32, s37
    s_lshl_b32 s45, s50, 7
    s_mul_i32 s46, s50, 196608
    s_waitcnt lgkmcnt(0)
    s_mov_b32 s4, s64
    s_mov_b32 s5, s65
    s_mov_b32 s6, 2621440
    s_mov_b32 s7, 0x20000
    s_mov_b32 s8, s72
    s_mov_b32 s9, s73
    s_mov_b32 s10, 1966080
    s_mov_b32 s11, 0x20000
    s_mov_b32 s12, s74
    s_mov_b32 s13, s75
    s_mov_b32 s14, 1966080
    s_mov_b32 s15, 0x20000
    s_mov_b32 s16, s82
    s_mov_b32 s17, s83
    s_mov_b32 s18, 268435456
    s_mov_b32 s19, 0x20000
    s_add_u32 m0, s42, 0
    s_nop 0
    buffer_load_dwordx4 v4, s[4:7], s45 offen lds
    s_waitcnt vmcnt(6)
    s_add_u32 m0, s42, 1024
    s_nop 0
    buffer_load_dwordx4 v5, s[4:7], s45 offen lds
    s_waitcnt vmcnt(6)
    s_add_u32 m0, s42, 2048
    s_nop 0
    buffer_load_dwordx4 v6, s[4:7], s45 offen lds
    s_waitcnt vmcnt(6)
    s_add_u32 m0, s42, 3072
    s_nop 0
    buffer_load_dwordx4 v7, s[4:7], s45 offen lds
    s_waitcnt vmcnt(6)
    s_add_u32 m0, s43, 0
    s_nop 0
    buffer_load_dwordx4 v8, s[8:11], s46 offen lds
    s_waitcnt vmcnt(6)
    s_lshl_b32 s38, s41, 4
    v_bfe_u32 v12, v0, 2, 2
    v_add_u32 v13, s38, v12
    v_and_b32 v14, 3, v0
    v_lshlrev_b32 v14, 3, v14
    v_lshrrev_b32 v16, 4, v0
    v_lshl_add_u32 v17, v16, 5, v14
    v_lshrrev_b32 v12, 1, v12
    v_lshlrev_b32 v12, 6, v12
    v_xor_b32 v17, v17, v12
    v_lshl_add_u32 v17, v13, 7, v17
    v_add_u32 v18, 49152, v17
    v_lshrrev_b32 v12, 1, v16
    v_xor_b32 v16, v16, v12
    v_and_b32 v16, 1, v16
    v_lshl_add_u32 v17, v16, 5, v14
    v_lshl_add_u32 v17, v13, 6, v17
    v_mul_u32_u24 v12, 12288, v12
    v_add_u32 v17, v17, v12
    v_add_u32 v19, 98304, v17
    v_lshlrev_b32 v12, 2, v0
    s_mul_i32 s38, s41, 768
    s_add_u32 s38, s38, 156160
    v_add_u32 v13, s38, v12
    s_lshl_b32 s38, s41, 8
    v_add_u32 v12, s38, v12
    v_add_u32 v14, 156160, v12
    s_mul_i32 s47, s33, 10
    s_add_u32 s47, s47, s50
    s_mul_i32 s47, s47, 768
    s_add_u32 s47, s47, 17825792
    s_add_u32 m0, s43, 1024
    s_nop 0
    buffer_load_dwordx4 v9, s[8:11], s46 offen lds
    s_waitcnt vmcnt(6)
    s_add_u32 m0, s44, 0
    s_nop 0
    buffer_load_dwordx4 v10, s[8:11], s46 offen lds
    s_waitcnt vmcnt(6)
    s_add_u32 m0, s43, 24576
    s_nop 0
    buffer_load_dwordx4 v8, s[12:15], s46 offen lds
    s_waitcnt vmcnt(6)
    s_add_u32 m0, s43, 25600
    s_nop 0
    buffer_load_dwordx4 v9, s[12:15], s46 offen lds
    s_waitcnt vmcnt(6)
    s_add_u32 m0, s44, 12288
    s_nop 0
    buffer_load_dwordx4 v11, s[12:15], s46 offen lds
    s_waitcnt vmcnt(6)
    s_add_u32 s45, s45, 128
    s_add_u32 s46, s46, 196608
    s_cmp_eq_u32 s45, 1280
    s_cselect_b32 s45, 0, s45
    s_cselect_b32 s46, 0, s46
    s_branch k_Lr2
k_Sr:
    s_setprio 3
    s_sub_u32 s41, s3, 8
    v_lshrrev_b32 v160, 5, v0
    v_lshlrev_b32 v160, 10, v160
    s_lshl_b32 s37, s41, 8
    s_add_u32 s37, s37, s34
    v_add_u32 v160, s37, v160
    v_mul_u32_u24 v160, 1280, v160
    v_and_b32 v162, 31, v0
    v_lshl_add_u32 v161, v162, 3, v160
    v_lshl_add_u32 v160, v162, 4, v160
    s_lshl_b32 s49, s31, 2
    s_add_u32 s49, s49, s41
    s_waitcnt lgkmcnt(0)
    s_mov_b32 s4, s64
    s_mov_b32 s5, s65
    s_mov_b32 s6, 2621440
    s_mov_b32 s7, 0x20000
    s_mov_b32 s16, s82
    s_mov_b32 s17, s83
    s_mov_b32 s18, 268435456
    s_mov_b32 s19, 0x20000
    s_cmp_lg_u32 s49, 3
    s_cbranch_scc1 k_init_x
    v_mul_u32_u24 v8, 384, v0
    s_mul_i32 s37, s30, 15360
    s_add_u32 s37, s37, 22020096
    v_mov_b32 v6, 0
    v_mov_b32 v7, 0
    s_mov_b32 exec_hi, 0xff
    buffer_store_dwordx4 v[4:7], v8, s[16:19], s37 offen sc1
    s_mov_b32 exec_hi, -1
k_init_x:
    buffer_load_dwordx4 v[4:7], v160, s[4:7], 0 offen
    buffer_load_dwordx4 v[8:11], v160, s[4:7], 0 offen offset:512
    buffer_load_dwordx2 v[12:13], v161, s[4:7], 0 offen offset:1024
    s_setprio 0
    v_and_b32 v106, 15, v0
    v_cvt_f32_u32 v106, v106
    v_lshrrev_b32 v107, 4, v0
    v_lshlrev_b32 v107, 2, v107
    v_cvt_f32_u32 v107, v107
    v_mul_f32 v121, 0x3d800000, v106
    v_add_f32 v108, 0x00000000, v107
    v_mul_f32 v108, v108, v121
    v_add_f32 v109, v108, v121
    v_add_f32 v110, v109, v121
    v_add_f32 v111, v110, v121
    v_cos_f32 v112, v108
    v_cos_f32 v113, v109
    v_cos_f32 v114, v110
    v_cos_f32 v115, v111
    v_sin_f32 v116, v108
    v_sin_f32 v117, v109
    v_sin_f32 v118, v110
    v_sin_f32 v119, v111
    v_cvt_pk_bf16_f32 v70, v112, v113
    v_cvt_pk_bf16_f32 v71, v114, v115
    v_cvt_pk_bf16_f32 v68, -v116, -v117
    v_cvt_pk_bf16_f32 v72, v116, v117
    v_cvt_pk_bf16_f32 v69, -v118, -v119
    v_cvt_pk_bf16_f32 v73, v118, v119
    v_add_f32 v120, 0x00000000, v106
    v_mul_f32 v121, 0x3ccccccd, v120
    v_add_f32 v108, 0x00000000, v107
    v_mul_f32 v108, v108, v121
    v_add_f32 v109, v108, v121
    v_add_f32 v110, v109, v121
    v_add_f32 v111, v110, v121
    v_cos_f32 v112, v108
    v_cos_f32 v113, v109
    v_cos_f32 v114, v110
    v_cos_f32 v115, v111
    v_sin_f32 v116, v108
    v_sin_f32 v117, v109
    v_sin_f32 v118, v110
    v_sin_f32 v119, v111
    v_cvt_pk_bf16_f32 v16, v112, v113
    v_cvt_pk_bf16_f32 v17, v114, v115
    v_cvt_pk_bf16_f32 v14, -v116, -v117
    v_cvt_pk_bf16_f32 v18, v116, v117
    v_cvt_pk_bf16_f32 v15, -v118, -v119
    v_cvt_pk_bf16_f32 v19, v118, v119
    v_add_f32 v108, 0x41800000, v107
    v_mul_f32 v108, v108, v121
    v_add_f32 v109, v108, v121
    v_add_f32 v110, v109, v121
    v_add_f32 v111, v110, v121
    v_cos_f32 v112, v108
    v_cos_f32 v113, v109
    v_cos_f32 v114, v110
    v_cos_f32 v115, v111
    v_sin_f32 v116, v108
    v_sin_f32 v117, v109
    v_sin_f32 v118, v110
    v_sin_f32 v119, v111
    v_cvt_pk_bf16_f32 v22, v112, v113
    v_cvt_pk_bf16_f32 v23, v114, v115
    v_cvt_pk_bf16_f32 v20, -v116, -v117
    v_cvt_pk_bf16_f32 v24, v116, v117
    v_cvt_pk_bf16_f32 v21, -v118, -v119
    v_cvt_pk_bf16_f32 v25, v118, v119
    v_mov_b32 v26, 0
    v_mov_b32 v27, 0
    v_mov_b32 v28, 0
    v_mov_b32 v29, 0
    v_mov_b32 v30, 0
    v_mov_b32 v31, 0
    s_mov_b32 exec_hi, 0
    v_add_f32 v108, 0x42000000, v107
    v_mul_f32 v108, v108, v121
    v_add_f32 v109, v108, v121
    v_add_f32 v110, v109, v121
    v_add_f32 v111, v110, v121
    v_cos_f32 v112, v108
    v_cos_f32 v113, v109
    v_cos_f32 v114, v110
    v_cos_f32 v115, v111
    v_sin_f32 v116, v108
    v_sin_f32 v117, v109
    v_sin_f32 v118, v110
    v_sin_f32 v119, v111
    v_cvt_pk_bf16_f32 v28, v112, v113
    v_cvt_pk_bf16_f32 v29, v114, v115
    v_cvt_pk_bf16_f32 v26, -v116, -v117
    v_cvt_pk_bf16_f32 v30, v116, v117
    v_cvt_pk_bf16_f32 v27, -v118, -v119
    v_cvt_pk_bf16_f32 v31, v118, v119
    s_mov_b32 exec_hi, -1
    v_mul_f32 v121, 0x3acccccd, v120
    v_add_f32 v108, 0x00000000, v107
    v_mul_f32 v108, v108, v121
    v_add_f32 v109, v108, v121
    v_add_f32 v110, v109, v121
    v_add_f32 v111, v110, v121
    v_cos_f32 v74, v108
    v_cos_f32 v75, v109
    v_cos_f32 v76, v110
    v_cos_f32 v77, v111
    v_sin_f32 v86, v108
    v_sin_f32 v87, v109
    v_sin_f32 v88, v110
    v_sin_f32 v89, v111
    v_add_f32 v120, 0x41800000, v106
    v_mul_f32 v121, 0x3ccccccd, v120
    v_add_f32 v108, 0x00000000, v107
    v_mul_f32 v108, v108, v121
    v_add_f32 v109, v108, v121
    v_add_f32 v110, v109, v121
    v_add_f32 v111, v110, v121
    v_cos_f32 v112, v108
    v_cos_f32 v113, v109
    v_cos_f32 v114, v110
    v_cos_f32 v115, v111
    v_sin_f32 v116, v108
    v_sin_f32 v117, v109
    v_sin_f32 v118, v110
    v_sin_f32 v119, v111
    v_cvt_pk_bf16_f32 v34, v112, v113
    v_cvt_pk_bf16_f32 v35, v114, v115
    v_cvt_pk_bf16_f32 v32, -v116, -v117
    v_cvt_pk_bf16_f32 v36, v116, v117
    v_cvt_pk_bf16_f32 v33, -v118, -v119
    v_cvt_pk_bf16_f32 v37, v118, v119
    v_add_f32 v108, 0x41800000, v107
    v_mul_f32 v108, v108, v121
    v_add_f32 v109, v108, v121
    v_add_f32 v110, v109, v121
    v_add_f32 v111, v110, v121
    v_cos_f32 v112, v108
    v_cos_f32 v113, v109
    v_cos_f32 v114, v110
    v_cos_f32 v115, v111
    v_sin_f32 v116, v108
    v_sin_f32 v117, v109
    v_sin_f32 v118, v110
    v_sin_f32 v119, v111
    v_cvt_pk_bf16_f32 v40, v112, v113
    v_cvt_pk_bf16_f32 v41, v114, v115
    v_cvt_pk_bf16_f32 v38, -v116, -v117
    v_cvt_pk_bf16_f32 v42, v116, v117
    v_cvt_pk_bf16_f32 v39, -v118, -v119
    v_cvt_pk_bf16_f32 v43, v118, v119
    v_mov_b32 v44, 0
    v_mov_b32 v45, 0
    v_mov_b32 v46, 0
    v_mov_b32 v47, 0
    v_mov_b32 v48, 0
    v_mov_b32 v49, 0
    s_mov_b32 exec_hi, 0
    v_add_f32 v108, 0x42000000, v107
    v_mul_f32 v108, v108, v121
    v_add_f32 v109, v108, v121
    v_add_f32 v110, v109, v121
    v_add_f32 v111, v110, v121
    v_cos_f32 v112, v108
    v_cos_f32 v113, v109
    v_cos_f32 v114, v110
    v_cos_f32 v115, v111
    v_sin_f32 v116, v108
    v_sin_f32 v117, v109
    v_sin_f32 v118, v110
    v_sin_f32 v119, v111
    v_cvt_pk_bf16_f32 v46, v112, v113
    v_cvt_pk_bf16_f32 v47, v114, v115
    v_cvt_pk_bf16_f32 v44, -v116, -v117
    v_cvt_pk_bf16_f32 v48, v116, v117
    v_cvt_pk_bf16_f32 v45, -v118, -v119
    v_cvt_pk_bf16_f32 v49, v118, v119
    s_mov_b32 exec_hi, -1
    v_mul_f32 v121, 0x3acccccd, v120
    v_add_f32 v108, 0x00000000, v107
    v_mul_f32 v108, v108, v121
    v_add_f32 v109, v108, v121
    v_add_f32 v110, v109, v121
    v_add_f32 v111, v110, v121
    v_cos_f32 v78, v108
    v_cos_f32 v79, v109
    v_cos_f32 v80, v110
    v_cos_f32 v81, v111
    v_sin_f32 v90, v108
    v_sin_f32 v91, v109
    v_sin_f32 v92, v110
    v_sin_f32 v93, v111
    v_add_f32 v120, 0x42000000, v106
    v_mul_f32 v121, 0x3ccccccd, v120
    v_add_f32 v108, 0x00000000, v107
    v_mul_f32 v108, v108, v121
    v_add_f32 v109, v108, v121
    v_add_f32 v110, v109, v121
    v_add_f32 v111, v110, v121
    v_cos_f32 v112, v108
    v_cos_f32 v113, v109
    v_cos_f32 v114, v110
    v_cos_f32 v115, v111
    v_sin_f32 v116, v108
    v_sin_f32 v117, v109
    v_sin_f32 v118, v110
    v_sin_f32 v119, v111
    v_cvt_pk_bf16_f32 v52, v112, v113
    v_cvt_pk_bf16_f32 v53, v114, v115
    v_cvt_pk_bf16_f32 v50, -v116, -v117
    v_cvt_pk_bf16_f32 v54, v116, v117
    v_cvt_pk_bf16_f32 v51, -v118, -v119
    v_cvt_pk_bf16_f32 v55, v118, v119
    v_add_f32 v108, 0x41800000, v107
    v_mul_f32 v108, v108, v121
    v_add_f32 v109, v108, v121
    v_add_f32 v110, v109, v121
    v_add_f32 v111, v110, v121
    v_cos_f32 v112, v108
    v_cos_f32 v113, v109
    v_cos_f32 v114, v110
    v_cos_f32 v115, v111
    v_sin_f32 v116, v108
    v_sin_f32 v117, v109
    v_sin_f32 v118, v110
    v_sin_f32 v119, v111
    v_cvt_pk_bf16_f32 v58, v112, v113
    v_cvt_pk_bf16_f32 v59, v114, v115
    v_cvt_pk_bf16_f32 v56, -v116, -v117
    v_cvt_pk_bf16_f32 v60, v116, v117
    v_cvt_pk_bf16_f32 v57, -v118, -v119
    v_cvt_pk_bf16_f32 v61, v118, v119
    v_mov_b32 v62, 0
    v_mov_b32 v63, 0
    v_mov_b32 v64, 0
    v_mov_b32 v65, 0
    v_mov_b32 v66, 0
    v_mov_b32 v67, 0
    s_mov_b32 exec_hi, 0
    v_add_f32 v108, 0x42000000, v107
    v_mul_f32 v108, v108, v121
    v_add_f32 v109, v108, v121
    v_add_f32 v110, v109, v121
    v_add_f32 v111, v110, v121
    v_cos_f32 v112, v108
    v_cos_f32 v113, v109
    v_cos_f32 v114, v110
    v_cos_f32 v115, v111
    v_sin_f32 v116, v108
    v_sin_f32 v117, v109
    v_sin_f32 v118, v110
    v_sin_f32 v119, v111
    v_cvt_pk_bf16_f32 v64, v112, v113
    v_cvt_pk_bf16_f32 v65, v114, v115
    v_cvt_pk_bf16_f32 v62, -v116, -v117
    v_cvt_pk_bf16_f32 v66, v116, v117
    v_cvt_pk_bf16_f32 v63, -v118, -v119
    v_cvt_pk_bf16_f32 v67, v118, v119
    s_mov_b32 exec_hi, -1
    v_mul_f32 v121, 0x3acccccd, v120
    v_add_f32 v108, 0x00000000, v107
    v_mul_f32 v108, v108, v121
    v_add_f32 v109, v108, v121
    v_add_f32 v110, v109, v121
    v_add_f32 v111, v110, v121
    v_cos_f32 v82, v108
    v_cos_f32 v83, v109
    v_cos_f32 v84, v110
    v_cos_f32 v85, v111
    v_sin_f32 v94, v108
    v_sin_f32 v95, v109
    v_sin_f32 v96, v110
    v_sin_f32 v97, v111
    v_and_b32 v106, 7, v0
    v_cvt_f32_u32 v107, v106
    v_and_b32 v108, 1, v0
    v_bfe_u32 v109, v0, 4, 1
    v_xor_b32 v108, v108, v109
    v_cvt_f32_u32 v108, v108
    v_mov_b32 v110, 0xbe000000
    v_fmac_f32 v110, 0x3e800000, v108
    v_cvt_f32_u32 v109, v109
    v_mov_b32 v111, -1.0
    v_fmac_f32 v111, 2.0, v109
    v_cvt_f32_u32 v112, s34
    v_mul_f32 v112, 0xba000000, v112
    v_fmac_f32 v110, v112, v107
    v_mul_f32 v107, 0xbe000000, v107
    v_bfe_u32 v113, v0, 3, 1
    v_lshrrev_b32 v114, 5, v0
    v_cmp_eq_u32 vcc, v113, v114
    v_mov_b32 v113, 0x3f3504f3
    s_nop 0
    v_cndmask_b32 v113, 0, v113, vcc
    v_mul_f32 v111, v111, v113
    v_cos_f32 v114, v110
    v_sin_f32 v115, v110
    v_add_f32 v110, v110, v107
    v_mul_f32 v116, v114, v113
    v_mul_f32 v117, v115, v111
    v_mul_f32 v118, v115, v113
    v_mul_f32 v119, v114, v111
    v_cvt_pk_bf16_f32 v98, v116, v117
    v_cvt_pk_bf16_f32 v102, v118, -v119
    v_cos_f32 v114, v110
    v_sin_f32 v115, v110
    v_add_f32 v110, v110, v107
    v_mul_f32 v116, v114, v113
    v_mul_f32 v117, v115, v111
    v_mul_f32 v118, v115, v113
    v_mul_f32 v119, v114, v111
    v_cvt_pk_bf16_f32 v99, v116, v117
    v_cvt_pk_bf16_f32 v103, v118, -v119
    v_cos_f32 v114, v110
    v_sin_f32 v115, v110
    v_add_f32 v110, v110, v107
    v_mul_f32 v116, v114, v113
    v_mul_f32 v117, v115, v111
    v_mul_f32 v118, v115, v113
    v_mul_f32 v119, v114, v111
    v_cvt_pk_bf16_f32 v100, v116, v117
    v_cvt_pk_bf16_f32 v104, v118, -v119
    v_cos_f32 v114, v110
    v_sin_f32 v115, v110
    v_add_f32 v110, v110, v107
    v_mul_f32 v116, v114, v113
    v_mul_f32 v117, v115, v111
    v_mul_f32 v118, v115, v113
    v_mul_f32 v119, v114, v111
    v_cvt_pk_bf16_f32 v101, v116, v117
    v_cvt_pk_bf16_f32 v105, v118, -v119
    s_mul_i32 s37, s41, 2592
    s_add_u32 s37, s37, 123392
    v_lshl_add_u32 v152, v0, 3, s37
    v_and_b32 v153, 31, v0
    v_lshl_add_u32 v153, v153, 3, s37
    v_lshrrev_b32 v154, 5, v0
    v_mul_u32_u24 v154, 1296, v154
    v_add_u32 v154, s37, v154
    v_lshl_add_u32 v155, v162, 3, v154
    v_lshl_add_u32 v154, v162, 4, v154
    v_and_b32 v106, 15, v0
    v_lshrrev_b32 v107, 4, v0
    v_mul_u32_u24 v156, 160, v106
    v_lshl_add_u32 v156, v107, 4, v156
    s_mul_i32 s37, s41, 2560
    s_add_u32 s37, s37, 133760
    v_add_u32 v156, s37, v156
    v_lshrrev_b32 v108, 5, v0
    v_lshl_add_u32 v108, v108, 4, v106
    s_lshl_b32 s38, s41, 5
    v_add_u32 v108, s38, v108
    v_sub_u32 v109, 640, v108
    v_and_b32 v107, 1, v107
    v_cmp_eq_u32 vcc, 1, v107
    s_nop 1
    v_cndmask_b32 v108, v108, v109, vcc
    v_mov_b32 v109, 512
    v_mov_b32 v110, -512
    v_cndmask_b32 v109, v109, v110, vcc
    v_lshlrev_b32 v110, 2, v108
    v_add_u32 v110, 133760, v110
    v_add_u32 v158, v110, v109
    v_add_u32 v159, v158, v109
    v_cmp_eq_u32 vcc, 640, v108
    v_mov_b32 v109, 133760
    s_nop 0
    v_cndmask_b32 v157, v110, v109, vcc
    v_bfe_u32 v106, v0, 2, 3
    v_mul_u32_u24 v106, 21, v106
    v_lshrrev_b32 v107, 5, v0
    v_add_u32 v106, v106, v107
    v_lshlrev_b32 v106, 14, v106
    v_bfe_u32 v107, v0, 3, 2
    v_xor_b32 v107, v107, v0
    v_and_b32 v107, 3, v107
    v_lshl_add_u32 v163, v107, 4, v106
    s_mul_i32 s38, s41, 2592
    s_add_u32 s38, s38, 123392
    v_lshl_add_u32 v167, v0, 4, s38
    v_bfe_u32 v106, v0, 1, 2
    v_lshrrev_b32 v107, 4, v0
    v_xor_b32 v106, v106, v107
    v_and_b32 v107, 15, v0
    v_lshl_add_u32 v106, v107, 2, v106
    v_lshl_add_u32 v166, v106, 4, s38
    s_lshl_b32 s43, s34, 6
    s_lshl_b32 s38, s41, 15
    s_add_u32 s43, s43, s38
    s_add_u32 s44, s43, 131072
    s_add_u32 s45, s43, 262144
    s_waitcnt vmcnt(0)
    s_setprio 3
    s_cmp_lg_u32 s49, 3
    s_cbranch_scc1 k_rdy_x
    s_lshl_b32 s37, s30, 2
    s_mov_b32 s62, 1
    s_atomic_add s62, s[80:81], s37 glc
k_rdy_x:
    s_mov_b32 s20, s66
    s_mov_b32 s21, s67
    s_mov_b32 s22, 1314816
    s_mov_b32 s23, 0x20000
    s_mov_b32 s24, s68
    s_mov_b32 s25, s69
    s_mov_b32 s26, 1314816
    s_mov_b32 s27, 0x20000
    s_lshr_b32 s50, s34, 2
    s_and_b32 s51, s34, 3
    s_lshl_b32 s37, s50, 4
    s_lshl_b32 s38, s41, 2
    s_add_u32 s37, s37, s38
    s_add_u32 s37, s37, s51
    s_mul_i32 s37, s37, 1284
    s_mul_i32 s38, s41, 1312
    s_add_u32 s38, s38, 144000
    v_lshlrev_b32 v106, 4, v0
    s_mov_b32 m0, s38
    s_nop 0
    buffer_load_dwordx4 v106, s[20:23], s37 offen  lds
    s_add_u32 m0, s38, 5248
    s_nop 0
    buffer_load_dwordx4 v106, s[24:27], s37 offen  lds
    s_mov_b64 exec, 0x1ffff
    s_mov_b32 m0, s38
    s_nop 0
    buffer_load_dwordx4 v106, s[20:23], s37 offen offset:1024  lds
    s_add_u32 m0, s38, 5248
    s_nop 0
    buffer_load_dwordx4 v106, s[24:27], s37 offen offset:1024  lds
    s_mov_b64 exec, -1
    s_cmp_lg_u32 s41, 0
    s_cbranch_scc1 k_nomir
    v_and_b32 v106, 3, v0
    v_bfe_u32 v107, v0, 4, 1
    v_lshl_add_u32 v106, v106, 3, v107
    s_lshl_b32 s37, s50, 5
    s_lshl_b32 s38, s51, 1
    s_add_u32 s37, s37, s38
    s_sub_u32 s37, 2048, s37
    v_sub_u32 v106, s37, v106
    v_and_b32 v106, 2047, v106
    v_mul_u32_u24 v106, 642, v106
    v_lshrrev_b32 v107, 5, v0
    v_mul_u32_u24 v107, 640, v107
    v_add_u32 v106, v106, v107
    s_mov_b32 exec_lo, 0x000f000f
    s_mov_b32 exec_hi, 0x000f000f
    buffer_load_short_d16_hi v138, v106, s[20:23], 0 offen
    buffer_load_short_d16_hi v139, v106, s[24:27], 0 offen
    s_mov_b64 exec, -1
k_nomir:
    v_lshlrev_b32 v106, 16, v4
    v_and_b32 v107, 0xffff0000, v4
    v_lshlrev_b32 v108, 16, v5
    v_and_b32 v109, 0xffff0000, v5
    v_lshlrev_b32 v110, 16, v6
    v_and_b32 v111, 0xffff0000, v6
    v_lshlrev_b32 v112, 16, v7
    v_and_b32 v113, 0xffff0000, v7
    v_lshlrev_b32 v114, 16, v8
    v_and_b32 v115, 0xffff0000, v8
    v_lshlrev_b32 v116, 16, v9
    v_and_b32 v117, 0xffff0000, v9
    v_lshlrev_b32 v118, 16, v10
    v_and_b32 v119, 0xffff0000, v10
    v_lshlrev_b32 v120, 16, v11
    v_and_b32 v121, 0xffff0000, v11
    v_lshlrev_b32 v122, 16, v12
    v_and_b32 v123, 0xffff0000, v12
    v_lshlrev_b32 v124, 16, v13
    v_and_b32 v125, 0xffff0000, v13
    v_add_f32 v126, v106, v107
    v_mul_f32 v127, v106, v106
    v_add_f32 v128, v108, v109
    v_mul_f32 v129, v107, v107
    v_fmac_f32 v127, v108, v108
    v_fmac_f32 v129, v109, v109
    v_add_f32 v126, v126, v110
    v_fmac_f32 v127, v110, v110
    v_add_f32 v128, v128, v111
    v_fmac_f32 v129, v111, v111
    v_add_f32 v126, v126, v112
    v_fmac_f32 v127, v112, v112
    v_add_f32 v128, v128, v113
    v_fmac_f32 v129, v113, v113
    v_add_f32 v126, v126, v114
    v_fmac_f32 v127, v114, v114
    v_add_f32 v128, v128, v115
    v_fmac_f32 v129, v115, v115
    v_add_f32 v126, v126, v116
    v_fmac_f32 v127, v116, v116
    v_add_f32 v128, v128, v117
    v_fmac_f32 v129, v117, v117
    v_add_f32 v126, v126, v118
    v_fmac_f32 v127, v118, v118
    v_add_f32 v128, v128, v119
    v_fmac_f32 v129, v119, v119
    v_add_f32 v126, v126, v120
    v_fmac_f32 v127, v120, v120
    v_add_f32 v128, v128, v121
    v_fmac_f32 v129, v121, v121
    v_add_f32 v126, v126, v122
    v_fmac_f32 v127, v122, v122
    v_add_f32 v128, v128, v123
    v_fmac_f32 v129, v123, v123
    v_add_f32 v126, v126, v124
    v_fmac_f32 v127, v124, v124
    v_add_f32 v128, v128, v125
    v_fmac_f32 v129, v125, v125
    v_add_f32 v126, v126, v128
    v_add_f32 v127, v127, v129
    s_nop 0
    v_add_f32_dpp v126, v126, v126 row_ror:8 row_mask:0xf bank_mask:0xf
    v_add_f32_dpp v127, v127, v127 row_ror:8 row_mask:0xf bank_mask:0xf
    s_nop 0
    v_add_f32_dpp v126, v126, v126 row_ror:4 row_mask:0xf bank_mask:0xf
    v_add_f32_dpp v127, v127, v127 row_ror:4 row_mask:0xf bank_mask:0xf
    s_nop 0
    v_add_f32_dpp v126, v126, v126 row_ror:2 row_mask:0xf bank_mask:0xf
    v_add_f32_dpp v127, v127, v127 row_ror:2 row_mask:0xf bank_mask:0xf
    s_nop 0
    v_add_f32_dpp v126, v126, v126 row_ror:1 row_mask:0xf bank_mask:0xf
    v_add_f32_dpp v127, v127, v127 row_ror:1 row_mask:0xf bank_mask:0xf
    v_mov_b32 v128, v126
    v_mov_b32 v129, v127
    s_nop 0
    v_permlane16_swap_b32 v126, v128
    v_permlane16_swap_b32 v127, v129
    v_add_f32 v126, v126, v128
    v_add_f32 v127, v127, v129
    v_mul_f32 v126, 0x3acccccd, v126
    v_mul_f32 v127, 0x3acccccd, v127
    v_fma_f32 v127, -v126, v126, v127
    v_max_f32 v127, 0, v127
    v_cvt_pk_bf16_f32 v128, v126, v127
    v_lshlrev_b32 v164, 16, v128
    v_and_b32 v127, 0xffff0000, v128
    v_add_f32 v127, 0x3727c5ac, v127
    v_cvt_pk_bf16_f32 v127, v127, v127
    v_and_b32 v127, 0xffff0000, v127
    v_sqrt_f32 v127, v127
    s_nop 0
    v_cvt_pk_bf16_f32 v127, v127, v127
    v_and_b32 v165, 0xffff0000, v127
    v_rcp_f32 v126, v165
    s_nop 0
    v_mul_f32 v128, v164, v126
    v_fma_f32 v106, v106, v126, -v128
    v_fma_f32 v107, v107, v126, -v128
    v_fma_f32 v108, v108, v126, -v128
    v_fma_f32 v109, v109, v126, -v128
    v_fma_f32 v110, v110, v126, -v128
    v_fma_f32 v111, v111, v126, -v128
    v_fma_f32 v112, v112, v126, -v128
    v_fma_f32 v113, v113, v126, -v128
    v_fma_f32 v114, v114, v126, -v128
    v_fma_f32 v115, v115, v126, -v128
    v_fma_f32 v116, v116, v126, -v128
    v_fma_f32 v117, v117, v126, -v128
    v_fma_f32 v118, v118, v126, -v128
    v_fma_f32 v119, v119, v126, -v128
    v_fma_f32 v120, v120, v126, -v128
    v_fma_f32 v121, v121, v126, -v128
    v_fma_f32 v122, v122, v126, -v128
    v_fma_f32 v123, v123, v126, -v128
    v_fma_f32 v124, v124, v126, -v128
    v_fma_f32 v125, v125, v126, -v128
    v_cvt_pk_bf16_f32 v106, v106, v107
    v_cvt_pk_bf16_f32 v107, v108, v109
    v_cvt_pk_bf16_f32 v108, v110, v111
    v_cvt_pk_bf16_f32 v109, v112, v113
    v_cvt_pk_bf16_f32 v110, v114, v115
    v_cvt_pk_bf16_f32 v111, v116, v117
    v_cvt_pk_bf16_f32 v112, v118, v119
    v_cvt_pk_bf16_f32 v113, v120, v121
    v_cvt_pk_bf16_f32 v114, v122, v123
    v_cvt_pk_bf16_f32 v115, v124, v125
    s_waitcnt lgkmcnt(0)
    ds_write_b128 v154, v[106:109]
    ds_write_b128 v154, v[110:113] offset:512
    ds_write_b64 v155, v[114:115] offset:1024
    ds_read_b64_tr_b16 v[140:141], v152 offset:0
    ds_read_b64_tr_b16 v[142:143], v152 offset:1296
    ds_read_b64_tr_b16 v[144:145], v152 offset:512
    ds_read_b64_tr_b16 v[146:147], v152 offset:1808
    ds_read_b64_tr_b16 v[148:149], v153 offset:1024
    ds_read_b64_tr_b16 v[150:151], v153 offset:2320
    s_waitcnt lgkmcnt(4)
    v_mfma_f32_16x16x32_bf16 v[106:109], v[140:143], v[16:19], 0
    v_mfma_f32_16x16x32_bf16 v[110:113], v[140:143], v[14:17], 0
    v_mfma_f32_16x16x32_bf16 v[114:117], v[140:143], v[34:37], 0
    v_mfma_f32_16x16x32_bf16 v[118:121], v[140:143], v[32:35], 0
    v_mfma_f32_16x16x32_bf16 v[122:125], v[140:143], v[52:55], 0
    v_mfma_f32_16x16x32_bf16 v[126:129], v[140:143], v[50:53], 0
    s_waitcnt lgkmcnt(2)
    v_mfma_f32_16x16x32_bf16 v[106:109], v[144:147], v[22:25], v[106:109]
    v_mfma_f32_16x16x32_bf16 v[110:113], v[144:147], v[20:23], v[110:113]
    v_mfma_f32_16x16x32_bf16 v[114:117], v[144:147], v[40:43], v[114:117]
    v_mfma_f32_16x16x32_bf16 v[118:121], v[144:147], v[38:41], v[118:121]
    v_mfma_f32_16x16x32_bf16 v[122:125], v[144:147], v[58:61], v[122:125]
    v_mfma_f32_16x16x32_bf16 v[126:129], v[144:147], v[56:59], v[126:129]
    s_waitcnt lgkmcnt(0)
    v_mfma_f32_16x16x32_bf16 v[106:109], v[148:151], v[28:31], v[106:109]
    v_mfma_f32_16x16x32_bf16 v[110:113], v[148:151], v[26:29], v[110:113]
    v_mfma_f32_16x16x32_bf16 v[114:117], v[148:151], v[46:49], v[114:117]
    v_mfma_f32_16x16x32_bf16 v[118:121], v[148:151], v[44:47], v[118:121]
    v_mfma_f32_16x16x32_bf16 v[122:125], v[148:151], v[64:67], v[122:125]
    v_mfma_f32_16x16x32_bf16 v[126:129], v[148:151], v[62:65], v[126:129]
    s_nop 2
    v_mul_f32 v130, v106, v74
    v_mul_f32 v134, v110, v74
    v_fmac_f32 v130, v110, v86
    v_fma_f32 v134, -v106, v86, v134
    v_mul_f32 v131, v107, v75
    v_mul_f32 v135, v111, v75
    v_fmac_f32 v131, v111, v87
    v_fma_f32 v135, -v107, v87, v135
    v_mul_f32 v132, v108, v76
    v_mul_f32 v136, v112, v76
    v_fmac_f32 v132, v112, v88
    v_fma_f32 v136, -v108, v88, v136
    v_mul_f32 v133, v109, v77
    v_mul_f32 v137, v113, v77
    v_fmac_f32 v133, v113, v89
    v_fma_f32 v137, -v109, v89, v137
    v_cvt_pk_bf16_f32 v140, v130, v131
    v_cvt_pk_bf16_f32 v141, v132, v133
    v_cvt_pk_bf16_f32 v142, v134, v135
    v_cvt_pk_bf16_f32 v143, v136, v137
    v_mul_f32 v130, v114, v78
    v_mul_f32 v134, v118, v78
    v_fmac_f32 v130, v118, v90
    v_fma_f32 v134, -v114, v90, v134
    v_mul_f32 v131, v115, v79
    v_mul_f32 v135, v119, v79
    v_fmac_f32 v131, v119, v91
    v_fma_f32 v135, -v115, v91, v135
    v_mul_f32 v132, v116, v80
    v_mul_f32 v136, v120, v80
    v_fmac_f32 v132, v120, v92
    v_fma_f32 v136, -v116, v92, v136
    v_mul_f32 v133, v117, v81
    v_mul_f32 v137, v121, v81
    v_fmac_f32 v133, v121, v93
    v_fma_f32 v137, -v117, v93, v137
    v_cvt_pk_bf16_f32 v144, v130, v131
    v_cvt_pk_bf16_f32 v145, v132, v133
    v_cvt_pk_bf16_f32 v146, v134, v135
    v_cvt_pk_bf16_f32 v147, v136, v137
    v_mul_f32 v130, v122, v82
    v_mul_f32 v134, v126, v82
    v_fmac_f32 v130, v126, v94
    v_fma_f32 v134, -v122, v94, v134
    v_mul_f32 v131, v123, v83
    v_mul_f32 v135, v127, v83
    v_fmac_f32 v131, v127, v95
    v_fma_f32 v135, -v123, v95, v135
    v_mul_f32 v132, v124, v84
    v_mul_f32 v136, v128, v84
    v_fmac_f32 v132, v128, v96
    v_fma_f32 v136, -v124, v96, v136
    v_mul_f32 v133, v125, v85
    v_mul_f32 v137, v129, v85
    v_fmac_f32 v133, v129, v97
    v_fma_f32 v137, -v125, v97, v137
    v_cvt_pk_bf16_f32 v148, v130, v131
    v_cvt_pk_bf16_f32 v149, v132, v133
    v_cvt_pk_bf16_f32 v150, v134, v135
    v_cvt_pk_bf16_f32 v151, v136, v137
    v_mfma_f32_16x16x32_bf16 v[106:109], v[140:143], v[70:73], 0
    v_mfma_f32_16x16x32_bf16 v[110:113], v[140:143], v[68:71], 0
    v_mfma_f32_16x16x32_bf16 v[114:117], v[144:147], v[70:73], 0
    v_mfma_f32_16x16x32_bf16 v[118:121], v[144:147], v[68:71], 0
    v_mfma_f32_16x16x32_bf16 v[122:125], v[148:151], v[70:73], 0
    v_mfma_f32_16x16x32_bf16 v[126:129], v[148:151], v[68:71], 0
    s_nop 3
    v_cvt_pk_bf16_f32 v140, v106, v110
    v_cvt_pk_bf16_f32 v141, v107, v111
    v_cvt_pk_bf16_f32 v142, v108, v112
    v_cvt_pk_bf16_f32 v143, v109, v113
    ds_write_b128 v156, v[140:143] offset:0
    v_cvt_pk_bf16_f32 v144, v114, v118
    v_cvt_pk_bf16_f32 v145, v115, v119
    v_cvt_pk_bf16_f32 v146, v116, v120
    v_cvt_pk_bf16_f32 v147, v117, v121
    ds_write_b128 v156, v[144:147] offset:64
    v_cvt_pk_bf16_f32 v148, v122, v126
    v_cvt_pk_bf16_f32 v149, v123, v127
    v_cvt_pk_bf16_f32 v150, v124, v128
    v_cvt_pk_bf16_f32 v151, v125, v129
    s_mov_b32 exec_hi, 0
    ds_write_b128 v156, v[148:151] offset:128
    s_mov_b32 exec_hi, -1
    s_waitcnt vmcnt(0)
    s_mov_b64 exec, 1
    ds_add_u32 v1, v2 offset:288
    s_mov_b64 exec, -1
k_x_2:
    ds_read_b32 v3, v1 offset:288
    ds_read2st64_b32 v[106:107], v157 offset0:0 offset1:10
    ds_read2st64_b32 v[108:109], v157 offset0:20 offset1:30
    ds_read2st64_b32 v[110:111], v158 offset0:0 offset1:10
    ds_read2st64_b32 v[112:113], v158 offset0:20 offset1:30
    ds_read2st64_b32 v[114:115], v159 offset0:0 offset1:10
    ds_read2st64_b32 v[116:117], v159 offset0:20 offset1:30
    s_add_u32 s35, s35, 1
    s_waitcnt lgkmcnt(6)
    v_readfirstlane_b32 s37, v3
    s_cmp_eq_u32 s37, 4
    s_cbranch_scc1 k_x_2_x
    s_cmp_lt_u32 s35, 2097152
    s_cbranch_scc1 k_x_2
k_x_2_x:
    s_waitcnt lgkmcnt(4)
    v_mfma_f32_16x16x32_bf16 v[14:17], v[106:109], v[98:101], 0
    v_mfma_f32_16x16x32_bf16 v[18:21], v[106:109], v[102:105], 0
    s_waitcnt lgkmcnt(2)
    v_mfma_f32_16x16x32_bf16 v[22:25], v[110:113], v[98:101], 0
    v_mfma_f32_16x16x32_bf16 v[26:29], v[110:113], v[102:105], 0
    s_waitcnt lgkmcnt(0)
    v_mfma_f32_16x16x32_bf16 v[30:33], v[114:117], v[98:101], 0
    v_mfma_f32_16x16x32_bf16 v[34:37], v[114:117], v[102:105], 0
    s_nop 1
    v_cvt_pk_bf16_f32 v142, v14, v18
    v_cvt_pk_bf16_f32 v143, v15, v19
    v_cvt_pk_bf16_f32 v144, v16, v20
    v_cvt_pk_bf16_f32 v145, v17, v21
    ds_write_b128 v166, v[142:145] offset:0
    ds_read_b128 v[106:109], v167 offset:0
    v_cvt_pk_bf16_f32 v146, v22, v26
    v_cvt_pk_bf16_f32 v147, v23, v27
    v_cvt_pk_bf16_f32 v148, v24, v28
    v_cvt_pk_bf16_f32 v149, v25, v29
    ds_write_b128 v166, v[146:149] offset:1024
    ds_read_b128 v[110:113], v167 offset:1024
    v_cvt_pk_bf16_f32 v150, v30, v34
    v_cvt_pk_bf16_f32 v151, v31, v35
    v_cvt_pk_bf16_f32 v152, v32, v36
    v_cvt_pk_bf16_f32 v153, v33, v37
    ds_write_b128 v166, v[150:153] offset:0
    ds_read_b128 v[114:117], v167 offset:0
    s_waitcnt lgkmcnt(4)
    buffer_store_dwordx4 v[106:109], v163, s[16:19], s43 offen sc1
    s_waitcnt lgkmcnt(2)
    buffer_store_dwordx4 v[110:113], v163, s[16:19], s44 offen sc1
    s_cmp_eq_u32 s41, 3
    s_cbranch_scc1 k_p1u
    s_cmp_eq_u32 s41, 2
    s_cselect_b32 exec_hi, 0, -1
    s_waitcnt lgkmcnt(0)
    buffer_store_dwordx4 v[114:117], v163, s[16:19], s45 offen sc1
    s_mov_b64 exec, -1
k_p1u:
    s_lshr_b32 s37, s34, 4
    s_lshl_b32 s37, s37, 7
    s_and_b32 s38, s34, 15
    s_add_u32 s37, s37, s38
    s_lshl_b32 s38, s41, 4
    s_add_u32 s37, s37, s38
    s_lshl_b32 s37, s37, 3
    s_add_u32 s37, s37, 18087936
    v_lshlrev_b32 v3, 4, v0
    s_mov_b32 exec_lo, 1
    s_mov_b32 exec_hi, 1
    buffer_store_dwordx2 v[164:165], v3, s[16:19], s37 offen sc1
    s_mov_b64 exec, -1
    s_cmp_lg_u32 s41, 3
    s_cbranch_scc1 k_rdy
    v_and_b32 v106, 7, v0
    v_lshlrev_b32 v106, 2, v106
    global_load_dword v107, v106, s[80:81] sc1
k_rdy:
    v_lshrrev_b32 v62, 5, v0
    s_lshl_b32 s37, s41, 1
    s_sub_u32 s37, s37, 1
    v_add_u32 v14, s37, v62
    v_add_u32 v15, 8, v14
    v_add_u32 v16, 16, v14
    v_mul_u32_u24 v62, 20, v62
    s_cmp_eq_u32 s41, 0
    s_cselect_b64 vcc, -1, 0
    v_cndmask_b32 v14, v14, v62, vcc
    v_bfe_u32 v62, v0, 4, 1
    v_and_b32 v17, 15, v0
    v_mul_u32_u24 v18, 642, v62
    v_lshl_add_u32 v18, v17, 1, v18
    v_add_u32 v18, 144000, v18
    v_mul_u32_u24 v19, 344064, v62
    v_lshl_add_u32 v19, v17, 4, v19
    s_mul_i32 s52, s51, 688128
    s_lshl_b32 s37, s50, 8
    s_add_u32 s52, s52, s37
    s_add_u32 s52, s52, 18874368
    v_lshl_add_u32 v20, v14, 5, v18
    v_lshl_add_u32 v14, v14, 14, v19
    v_lshl_add_u32 v21, v15, 5, v18
    v_lshl_add_u32 v15, v15, 14, v19
    v_lshl_add_u32 v22, v16, 5, v18
    v_lshl_add_u32 v16, v16, 14, v19
    ds_read_u16 v24, v20 offset:0
    ds_read_u16 v44, v20 offset:5248
    ds_read_u16 v25, v20 offset:1312
    ds_read_u16 v45, v20 offset:6560
    ds_read_u16 v26, v20 offset:2624
    ds_read_u16 v46, v20 offset:7872
    ds_read_u16 v27, v20 offset:3936
    ds_read_u16 v47, v20 offset:9184
    ds_read_u16 v28, v21 offset:0
    ds_read_u16 v48, v21 offset:5248
    ds_read_u16 v29, v21 offset:1312
    ds_read_u16 v49, v21 offset:6560
    ds_read_u16 v30, v21 offset:2624
    ds_read_u16 v50, v21 offset:7872
    ds_read_u16 v31, v21 offset:3936
    ds_read_u16 v51, v21 offset:9184
    ds_read_u16 v32, v22 offset:0
    ds_read_u16 v52, v22 offset:5248
    ds_read_u16 v33, v22 offset:1312
    ds_read_u16 v53, v22 offset:6560
    ds_read_u16 v34, v22 offset:2624
    ds_read_u16 v54, v22 offset:7872
    ds_read_u16 v35, v22 offset:3936
    ds_read_u16 v55, v22 offset:9184
    s_waitcnt lgkmcnt(0)
    v_lshl_or_b32 v24, v44, 16, v24
    v_lshl_or_b32 v25, v45, 16, v25
    v_lshl_or_b32 v26, v46, 16, v26
    v_lshl_or_b32 v27, v47, 16, v27
    v_lshl_or_b32 v28, v48, 16, v28
    v_lshl_or_b32 v29, v49, 16, v29
    v_lshl_or_b32 v30, v50, 16, v30
    v_lshl_or_b32 v31, v51, 16, v31
    v_lshl_or_b32 v32, v52, 16, v32
    v_lshl_or_b32 v33, v53, 16, v33
    v_lshl_or_b32 v34, v54, 16, v34
    v_lshl_or_b32 v35, v55, 16, v35
    s_cmp_lg_u32 s41, 0
    s_cbranch_scc1 k_nofix
    v_mov_b32_dpp v36, v138 quad_perm:[0,0,0,0] row_mask:0xf bank_mask:0xf
    v_mov_b32_dpp v56, v139 quad_perm:[0,0,0,0] row_mask:0xf bank_mask:0xf
    v_mov_b32_dpp v37, v138 quad_perm:[1,1,1,1] row_mask:0xf bank_mask:0xf
    v_mov_b32_dpp v57, v139 quad_perm:[1,1,1,1] row_mask:0xf bank_mask:0xf
    v_mov_b32_dpp v38, v138 quad_perm:[2,2,2,2] row_mask:0xf bank_mask:0xf
    v_mov_b32_dpp v58, v139 quad_perm:[2,2,2,2] row_mask:0xf bank_mask:0xf
    v_mov_b32_dpp v39, v138 quad_perm:[3,3,3,3] row_mask:0xf bank_mask:0xf
    v_mov_b32_dpp v59, v139 quad_perm:[3,3,3,3] row_mask:0xf bank_mask:0xf
    s_mov_b32 exec_lo, 0x00010001
    s_mov_b32 exec_hi, 0x00010001
    v_lshlrev_b32 v40, 16, v24
    v_and_b32 v41, 0xffff0000, v24
    v_and_b32 v42, 0xffff0000, v36
    v_and_b32 v43, 0xffff0000, v56
    v_add_f32 v40, v40, v42
    v_sub_f32 v41, v41, v43
    v_mul_f32 v40, 0.5, v40
    v_mul_f32 v41, 0.5, v41
    v_cvt_pk_bf16_f32 v24, v40, v41
    v_lshlrev_b32 v40, 16, v25
    v_and_b32 v41, 0xffff0000, v25
    v_and_b32 v42, 0xffff0000, v37
    v_and_b32 v43, 0xffff0000, v57
    v_add_f32 v40, v40, v42
    v_sub_f32 v41, v41, v43
    v_mul_f32 v40, 0.5, v40
    v_mul_f32 v41, 0.5, v41
    v_cvt_pk_bf16_f32 v25, v40, v41
    v_lshlrev_b32 v40, 16, v26
    v_and_b32 v41, 0xffff0000, v26
    v_and_b32 v42, 0xffff0000, v38
    v_and_b32 v43, 0xffff0000, v58
    v_add_f32 v40, v40, v42
    v_sub_f32 v41, v41, v43
    v_mul_f32 v40, 0.5, v40
    v_mul_f32 v41, 0.5, v41
    v_cvt_pk_bf16_f32 v26, v40, v41
    v_lshlrev_b32 v40, 16, v27
    v_and_b32 v41, 0xffff0000, v27
    v_and_b32 v42, 0xffff0000, v39
    v_and_b32 v43, 0xffff0000, v59
    v_add_f32 v40, v40, v42
    v_sub_f32 v41, v41, v43
    v_mul_f32 v40, 0.5, v40
    v_mul_f32 v41, 0.5, v41
    v_cvt_pk_bf16_f32 v27, v40, v41
    s_mov_b64 exec, -1
k_nofix:
    buffer_store_dwordx4 v[24:27], v14, s[16:19], s52 offen sc1
    buffer_store_dwordx4 v[28:31], v15, s[16:19], s52 offen sc1
    s_cmp_eq_u32 s41, 3
    s_cbranch_scc1 k_wt3
    s_cmp_eq_u32 s41, 2
    s_cselect_b32 exec_hi, 0, -1
    buffer_store_dwordx4 v[32:35], v16, s[16:19], s52 offen sc1
    s_mov_b64 exec, -1
k_wt3:
    s_cmp_lg_u32 s41, 3
    s_cbranch_scc1 k_rdy2
k_rdyp:
    s_waitcnt vmcnt(0)
    v_cmp_eq_u32 vcc, 0, v107
    s_add_u32 s35, s35, 1
    s_cmp_eq_u64 vcc, 0
    s_cbranch_scc1 k_rdyp_x
    s_sleep 4
    global_load_dword v107, v106, s[80:81] sc1
    s_cmp_lt_u32 s35, 2097152
    s_cbranch_scc1 k_rdyp
k_rdyp_x:
    s_mov_b64 exec, 1
    ds_add_u32 v1, v2 offset:280
    s_mov_b64 exec, -1
k_rdy2:
    s_waitcnt vmcnt(0)
    s_mov_b64 exec, 1
    ds_add_rtn_u32 v3, v1, v2 offset:292
    s_mov_b64 exec, -1
    s_waitcnt lgkmcnt(0)
    v_readfirstlane_b32 s37, v3
    s_cmp_lg_u32 s37, 3
    s_cbranch_scc1 k_pub_3
k_w_4:
    ds_read_b32 v3, v1 offset:332
    s_waitcnt lgkmcnt(0)
    v_readfirstlane_b32 s37, v3
    s_add_u32 s35, s35, 1
    s_cmp_eq_u32 s37, 4
    s_cbranch_scc1 k_w_4_x
    s_cmp_lt_u32 s35, 2097152
    s_cbranch_scc1 k_w_4
k_w_4_x:
    s_mul_i32 s60, s30, 384
    s_add_u32 s60, s60, 22020096
    s_mov_b32 s61, 1
    s_atomic_add s61, s[82:83], s60 glc
    s_mov_b32 s60, 22118400
    v_mul_u32_u24 v3, 384, v0
    s_waitcnt lgkmcnt(0)
    s_cmp_lg_u32 s61, 31
    s_cbranch_scc1 k_pub_3
    s_mov_b32 exec_hi, 0
    buffer_atomic_add v2, v3, s[16:19], s60 offen sc1
    s_mov_b32 exec_hi, -1
k_pub_3:
k_w_5:
    ds_read_b32 v3, v1 offset:332
    s_waitcnt lgkmcnt(0)
    v_readfirstlane_b32 s37, v3
    s_add_u32 s35, s35, 1
    s_cmp_eq_u32 s37, 4
    s_cbranch_scc1 k_w_5_x
    s_cmp_lt_u32 s35, 2097152
    s_cbranch_scc1 k_w_5
k_w_5_x:
    s_mov_b32 s8, s76
    s_mov_b32 s9, s77
    s_mov_b32 s10, 1966080
    s_mov_b32 s11, 0x20000
    s_mul_i32 s37, s31, 61440
    s_mul_i32 s38, s30, 160
    s_add_u32 s37, s37, s38
    s_lshl_b32 s38, s41, 7
    s_lshl_b32 s39, s41, 11
    s_cmp_eq_u32 s41, 3
    s_cselect_b32 s40, 0, -1
    v_add_u32 v106, s38, v0
    v_mul_u32_u24 v107, 6554, v106
    v_lshrrev_b32 v107, 16, v107
    v_mul_u32_u24 v108, 10, v107
    v_sub_u32 v108, v106, v108
    v_mul_u32_u24 v107, 1280, v107
    v_lshl_add_u32 v107, v108, 4, v107
    s_add_u32 m0, s39, 156160
    s_nop 0
    buffer_load_dwordx4 v107, s[8:11], s37 offen lds
    v_add_u32 v106, s38, v0
    v_add_u32 v106, 64, v106
    v_mul_u32_u24 v107, 6554, v106
    v_lshrrev_b32 v107, 16, v107
    v_mul_u32_u24 v108, 10, v107
    v_sub_u32 v108, v106, v108
    v_mul_u32_u24 v107, 1280, v107
    v_lshl_add_u32 v107, v108, 4, v107
    s_add_u32 m0, s39, 157184
    s_mov_b32 exec_hi, s40
    buffer_load_dwordx4 v107, s[8:11], s37 offen lds
    s_mov_b32 exec_hi, -1
    s_cmp_ge_u32 s31, 21
    s_cbranch_scc1 k_w2c
    s_setprio 0
    v_and_b32 v102, 15, v0
    v_cvt_f32_u32 v102, v102
    v_mul_f32 v102, 0x3b800000, v102
    v_lshrrev_b32 v103, 4, v0
    v_lshlrev_b32 v103, 6, v103
    v_cvt_f32_u32 v103, v103
    v_mul_f32 v104, 0x41800000, v102
    s_lshl_b32 s37, s41, 2
    v_cvt_f32_u32 v105, s37
    v_add_f32 v105, v105, v103
    v_add_f32 v106, 0x00000000, v105
    v_mul_f32 v106, v106, v102
    v_add_f32 v107, v106, v104
    v_add_f32 v108, v107, v104
    v_add_f32 v109, v108, v104
    v_cos_f32 v110, v106
    v_cos_f32 v111, v107
    v_cos_f32 v112, v108
    v_cos_f32 v113, v109
    v_sin_f32 v114, v106
    v_sin_f32 v115, v107
    v_sin_f32 v116, v108
    v_sin_f32 v117, v109
    v_cvt_pk_bf16_f32 v14, v110, v114
    v_cvt_pk_bf16_f32 v18, -v114, v110
    v_cvt_pk_bf16_f32 v15, v111, v115
    v_cvt_pk_bf16_f32 v19, -v115, v111
    v_cvt_pk_bf16_f32 v16, v112, v116
    v_cvt_pk_bf16_f32 v20, -v116, v112
    v_cvt_pk_bf16_f32 v17, v113, v117
    v_cvt_pk_bf16_f32 v21, -v117, v113
    v_add_f32 v106, 0x3f800000, v105
    v_mul_f32 v106, v106, v102
    v_add_f32 v107, v106, v104
    v_add_f32 v108, v107, v104
    v_add_f32 v109, v108, v104
    v_cos_f32 v110, v106
    v_cos_f32 v111, v107
    v_cos_f32 v112, v108
    v_cos_f32 v113, v109
    v_sin_f32 v114, v106
    v_sin_f32 v115, v107
    v_sin_f32 v116, v108
    v_sin_f32 v117, v109
    v_cvt_pk_bf16_f32 v22, v110, v114
    v_cvt_pk_bf16_f32 v26, -v114, v110
    v_cvt_pk_bf16_f32 v23, v111, v115
    v_cvt_pk_bf16_f32 v27, -v115, v111
    v_cvt_pk_bf16_f32 v24, v112, v116
    v_cvt_pk_bf16_f32 v28, -v116, v112
    v_cvt_pk_bf16_f32 v25, v113, v117
    v_cvt_pk_bf16_f32 v29, -v117, v113
    v_add_f32 v106, 0x40000000, v105
    v_mul_f32 v106, v106, v102
    v_add_f32 v107, v106, v104
    v_add_f32 v108, v107, v104
    v_add_f32 v109, v108, v104
    v_cos_f32 v110, v106
    v_cos_f32 v111, v107
    v_cos_f32 v112, v108
    v_cos_f32 v113, v109
    v_sin_f32 v114, v106
    v_sin_f32 v115, v107
    v_sin_f32 v116, v108
    v_sin_f32 v117, v109
    v_cvt_pk_bf16_f32 v30, v110, v114
    v_cvt_pk_bf16_f32 v34, -v114, v110
    v_cvt_pk_bf16_f32 v31, v111, v115
    v_cvt_pk_bf16_f32 v35, -v115, v111
    v_cvt_pk_bf16_f32 v32, v112, v116
    v_cvt_pk_bf16_f32 v36, -v116, v112
    v_cvt_pk_bf16_f32 v33, v113, v117
    v_cvt_pk_bf16_f32 v37, -v117, v113
    v_add_f32 v106, 0x40400000, v105
    v_mul_f32 v106, v106, v102
    v_add_f32 v107, v106, v104
    v_add_f32 v108, v107, v104
    v_add_f32 v109, v108, v104
    v_cos_f32 v110, v106
    v_cos_f32 v111, v107
    v_cos_f32 v112, v108
    v_cos_f32 v113, v109
    v_sin_f32 v114, v106
    v_sin_f32 v115, v107
    v_sin_f32 v116, v108
    v_sin_f32 v117, v109
    v_cvt_pk_bf16_f32 v38, v110, v114
    v_cvt_pk_bf16_f32 v42, -v114, v110
    v_cvt_pk_bf16_f32 v39, v111, v115
    v_cvt_pk_bf16_f32 v43, -v115, v111
    v_cvt_pk_bf16_f32 v40, v112, v116
    v_cvt_pk_bf16_f32 v44, -v116, v112
    v_cvt_pk_bf16_f32 v41, v113, v117
    v_cvt_pk_bf16_f32 v45, -v117, v113
    v_mul_f32 v106, v103, v102
    v_add_f32 v107, v106, v104
    v_add_f32 v108, v107, v104
    v_add_f32 v109, v108, v104
    v_cos_f32 v110, v106
    v_cos_f32 v111, v107
    v_cos_f32 v112, v108
    v_cos_f32 v113, v109
    v_sin_f32 v114, v106
    v_sin_f32 v115, v107
    v_sin_f32 v116, v108
    v_sin_f32 v117, v109
    v_cvt_pk_bf16_f32 v46, v110, v114
    v_cvt_pk_bf16_f32 v50, -v114, v110
    v_cvt_pk_bf16_f32 v47, v111, v115
    v_cvt_pk_bf16_f32 v51, -v115, v111
    v_cvt_pk_bf16_f32 v48, v112, v116
    v_cvt_pk_bf16_f32 v52, -v116, v112
    v_cvt_pk_bf16_f32 v49, v113, v117
    v_cvt_pk_bf16_f32 v53, -v117, v113
    v_lshrrev_b32 v149, 4, v0
    v_and_b32 v151, 15, v0
    s_lshl_b32 s37, s41, 8
    v_lshlrev_b32 v150, 10, v149
    v_lshl_add_u32 v150, v151, 4, v150
    v_add_u32 v150, s37, v150
    v_lshlrev_b32 v152, 12, v149
    v_lshl_add_u32 v152, v151, 4, v152
    v_add_u32 v157, s37, v152
    s_add_u32 s37, s37, 123392
    v_lshlrev_b32 v155, 10, v149
    v_lshl_add_u32 v155, v151, 2, v155
    v_add_u32 v151, s37, v152
    s_lshl_b32 s37, s41, 12
    s_add_u32 s45, s37, 139776
    s_add_u32 s37, s37, 123392
    v_lshl_add_u32 v153, v0, 4, s37
    v_add_u32 v156, s37, v155
    v_add_u32 v155, s45, v155
    v_lshlrev_b32 v149, 13, v149
    v_bfe_u32 v152, v0, 2, 2
    v_lshl_add_u32 v149, v152, 9, v149
    v_and_b32 v152, 3, v0
    v_lshl_add_u32 v152, v152, 4, v149
    s_mul_i32 s43, s30, 21
    s_add_u32 s43, s43, s31
    s_lshl_b32 s43, s43, 14
    s_lshl_b32 s44, s31, 17
    s_lshl_b32 s37, s41, 11
    s_add_u32 s44, s44, s37
    s_lshl_b32 s37, s30, 6
    s_add_u32 s44, s44, s37
    s_add_u32 s44, s44, 3145728
    s_add_u32 s47, s43, 18874368
k_w2c:
    s_setprio 3
    s_waitcnt vmcnt(0)
    s_waitcnt lgkmcnt(0)
    s_mov_b64 exec, 1
    ds_add_u32 v1, v2 offset:376
    s_mov_b64 exec, -1
k_w_6:
    ds_read_b32 v3, v1 offset:376
    s_waitcnt lgkmcnt(0)
    v_readfirstlane_b32 s37, v3
    s_add_u32 s35, s35, 1
    s_cmp_eq_u32 s37, 4
    s_cbranch_scc1 k_w_6_x
    s_cmp_lt_u32 s35, 2097152
    s_cbranch_scc1 k_w_6
k_w_6_x:
    s_bitcmp0_b32 s41, 0
    s_cbranch_scc1 k_w2skip
    s_cmp_eq_u32 s41, 3
    s_cselect_b32 s39, -1, 0
    s_cselect_b32 s38, 0, 2
    v_lshrrev_b32 v64, 5, v0
    v_and_b32 v64, s39, v64
    v_add_u32 v64, s38, v64
    v_bfe_u32 v65, v0, 2, 3
    v_lshl_add_u32 v65, v64, 4, v65
    v_mul_u32_u24 v65, 160, v65
    v_add_u32 v65, 156160, v65
    v_and_b32 v66, 3, v0
    v_lshl_add_u32 v67, v66, 3, v65
    v_lshl_add_u32 v66, v66, 4, v65
    ds_read_b64_tr_b16 v[68:69], v66 offset:0
    ds_read_b64_tr_b16 v[70:71], v66 offset:1280
    ds_read_b64_tr_b16 v[72:73], v66 offset:8
    ds_read_b64_tr_b16 v[74:75], v66 offset:1288
    ds_read_b64_tr_b16 v[76:77], v66 offset:64
    ds_read_b64_tr_b16 v[78:79], v66 offset:1344
    ds_read_b64_tr_b16 v[80:81], v66 offset:72
    ds_read_b64_tr_b16 v[82:83], v66 offset:1352
    ds_read_b64_tr_b16 v[84:85], v67 offset:128
    ds_read_b64_tr_b16 v[86:87], v67 offset:1408
    s_mul_i32 s37, s31, 3
    v_add_u32 v64, s37, v64
    v_lshrrev_b32 v65, 1, v64
    v_mul_u32_u24 v65, 5120, v65
    v_and_b32 v64, 1, v64
    v_lshl_add_u32 v65, v64, 9, v65
    v_lshl_add_u32 v65, v162, 4, v65
    s_mul_i32 s37, s30, 245760
    s_add_u32 s37, s37, 12582912
    s_add_u32 s38, s37, 4096
    s_mov_b32 exec_hi, s39
    s_waitcnt lgkmcnt(8)
    buffer_store_dwordx4 v[68:71], v65, s[16:19], s37 offen offset:0 sc1
    s_waitcnt lgkmcnt(6)
    buffer_store_dwordx4 v[72:75], v65, s[16:19], s37 offen offset:1024 sc1
    s_waitcnt lgkmcnt(4)
    buffer_store_dwordx4 v[76:79], v65, s[16:19], s37 offen offset:2048 sc1
    s_waitcnt lgkmcnt(2)
    buffer_store_dwordx4 v[80:83], v65, s[16:19], s37 offen offset:3072 sc1
    s_waitcnt lgkmcnt(0)
    buffer_store_dwordx4 v[84:87], v65, s[16:19], s38 offen offset:0 sc1
    s_mov_b32 exec_hi, -1
k_w2skip:
    s_mul_i32 s53, s30, 384
    s_add_u32 s53, s53, 22026240
    s_mul_i32 s48, s31, 384
    s_add_u32 s48, s48, 22118400
    s_cmp_ge_u32 s31, 21
    s_cbranch_scc1 k_notask
    s_setprio 0
    s_setprio 3
    s_cmp_lg_u32 s41, 0
    s_cbranch_scc1 k_p2go
k_s_7:
    s_load_dword s37, s[82:83], s48 glc
    s_add_u32 s35, s35, 1
    s_waitcnt lgkmcnt(0)
    s_cmp_eq_u32 s37, 8
    s_cbranch_scc1 k_s_7_x
    s_sleep 2
    s_cmp_lt_u32 s35, 2097152
    s_cbranch_scc1 k_s_7
k_s_7_x:
k_p2go:
    s_waitcnt lgkmcnt(0)
    s_mov_b64 exec, 1
    ds_add_u32 v1, v2 offset:304
    s_mov_b64 exec, -1
k_w_8:
    ds_read_b32 v3, v1 offset:304
    s_waitcnt lgkmcnt(0)
    v_readfirstlane_b32 s37, v3
    s_add_u32 s35, s35, 1
    s_cmp_eq_u32 s37, 4
    s_cbranch_scc1 k_w_8_x
    s_sleep 1
    s_cmp_lt_u32 s35, 2097152
    s_cbranch_scc1 k_w_8
k_w_8_x:
    s_add_u32 m0, s45, 0
    s_nop 0
    buffer_load_dwordx4 v150, s[16:19], s43 offen sc1 lds
    s_add_u32 s43, s43, 4096
    s_add_u32 m0, s45, 1024
    s_nop 0
    buffer_load_dwordx4 v150, s[16:19], s43 offen sc1 lds
    s_add_u32 s43, s43, 4096
    s_add_u32 m0, s45, 2048
    s_nop 0
    buffer_load_dwordx4 v150, s[16:19], s43 offen sc1 lds
    s_add_u32 s43, s43, 4096
    s_add_u32 m0, s45, 3072
    s_nop 0
    buffer_load_dwordx4 v150, s[16:19], s43 offen sc1 lds
    s_add_u32 s43, s43, 4096
    buffer_load_dwordx4 v[70:73], v157, s[16:19], s47 offen offset:0 sc1
    buffer_load_dwordx4 v[74:77], v157, s[16:19], s47 offen offset:1024 sc1
    buffer_load_dwordx4 v[78:81], v157, s[16:19], s47 offen offset:2048 sc1
    buffer_load_dwordx4 v[82:85], v157, s[16:19], s47 offen offset:3072 sc1
    s_waitcnt vmcnt(4)
    s_mov_b64 exec, 1
    ds_add_rtn_u32 v3, v1, v2 offset:300
    s_mov_b64 exec, -1
    s_waitcnt lgkmcnt(0)
    v_readfirstlane_b32 s37, v3
    s_cmp_lg_u32 s37, 3
    s_cbranch_scc1 k_pub_9
    s_mov_b64 exec, 1
    ds_add_u32 v1, v2 offset:336
    s_mov_b64 exec, -1
    s_mov_b64 exec, 1
    buffer_atomic_add v2, off, s[16:19], s53 sc1
    s_mov_b64 exec, -1
k_pub_9:
    ds_read2st64_b32 v[86:87], v155 offset0:0 offset1:1
    ds_read2st64_b32 v[88:89], v155 offset0:2 offset1:3
    v_add_u32 v155, 64, v155
    ds_read2st64_b32 v[90:91], v155 offset0:0 offset1:1
    ds_read2st64_b32 v[92:93], v155 offset0:2 offset1:3
    v_add_u32 v155, 64, v155
    ds_read2st64_b32 v[94:95], v155 offset0:0 offset1:1
    ds_read2st64_b32 v[96:97], v155 offset0:2 offset1:3
    v_add_u32 v155, 64, v155
    ds_read2st64_b32 v[98:99], v155 offset0:0 offset1:1
    ds_read2st64_b32 v[100:101], v155 offset0:2 offset1:3
    s_waitcnt lgkmcnt(6)
    v_mfma_f32_16x16x32_bf16 v[102:105], v[14:17], v[86:89], 0
    v_mfma_f32_16x16x32_bf16 v[106:109], v[18:21], v[86:89], 0
    s_waitcnt lgkmcnt(4)
    v_mfma_f32_16x16x32_bf16 v[110:113], v[22:25], v[90:93], 0
    v_mfma_f32_16x16x32_bf16 v[114:117], v[26:29], v[90:93], 0
    s_waitcnt lgkmcnt(2)
    v_mfma_f32_16x16x32_bf16 v[118:121], v[30:33], v[94:97], 0
    v_mfma_f32_16x16x32_bf16 v[122:125], v[34:37], v[94:97], 0
    s_waitcnt lgkmcnt(0)
    v_mfma_f32_16x16x32_bf16 v[126:129], v[38:41], v[98:101], 0
    v_mfma_f32_16x16x32_bf16 v[130:133], v[42:45], v[98:101], 0
    v_cvt_pk_bf16_f32 v134, v102, v106
    v_cvt_pk_bf16_f32 v138, v103, v107
    v_cvt_pk_bf16_f32 v142, v104, v108
    v_cvt_pk_bf16_f32 v146, v105, v109
    v_cvt_pk_bf16_f32 v135, v110, v114
    v_cvt_pk_bf16_f32 v139, v111, v115
    v_cvt_pk_bf16_f32 v143, v112, v116
    v_cvt_pk_bf16_f32 v147, v113, v117
    v_cvt_pk_bf16_f32 v136, v118, v122
    v_cvt_pk_bf16_f32 v140, v119, v123
    v_cvt_pk_bf16_f32 v144, v120, v124
    v_cvt_pk_bf16_f32 v148, v121, v125
    v_cvt_pk_bf16_f32 v137, v126, v130
    v_cvt_pk_bf16_f32 v141, v127, v131
    v_cvt_pk_bf16_f32 v145, v128, v132
    v_cvt_pk_bf16_f32 v149, v129, v133
    ds_write_b128 v151, v[134:137] offset:0
    ds_write_b128 v151, v[138:141] offset:1024
    ds_write_b128 v151, v[142:145] offset:2048
    ds_write_b128 v151, v[146:149] offset:3072
    s_mov_b64 exec, 1
    ds_add_u32 v1, v2 offset:308
    s_mov_b64 exec, -1
    s_waitcnt vmcnt(0)
    v_lshlrev_b32 v54, 16, v70
    v_and_b32 v70, 0xffff0000, v70
    v_lshlrev_b32 v55, 16, v71
    v_and_b32 v71, 0xffff0000, v71
    v_lshlrev_b32 v56, 16, v72
    v_and_b32 v72, 0xffff0000, v72
    v_lshlrev_b32 v57, 16, v73
    v_and_b32 v73, 0xffff0000, v73
    v_lshlrev_b32 v58, 16, v74
    v_and_b32 v74, 0xffff0000, v74
    v_lshlrev_b32 v59, 16, v75
    v_and_b32 v75, 0xffff0000, v75
    v_lshlrev_b32 v60, 16, v76
    v_and_b32 v76, 0xffff0000, v76
    v_lshlrev_b32 v61, 16, v77
    v_and_b32 v77, 0xffff0000, v77
    v_lshlrev_b32 v62, 16, v78
    v_and_b32 v78, 0xffff0000, v78
    v_lshlrev_b32 v63, 16, v79
    v_and_b32 v79, 0xffff0000, v79
    v_lshlrev_b32 v64, 16, v80
    v_and_b32 v80, 0xffff0000, v80
    v_lshlrev_b32 v65, 16, v81
    v_and_b32 v81, 0xffff0000, v81
    v_lshlrev_b32 v66, 16, v82
    v_and_b32 v82, 0xffff0000, v82
    v_lshlrev_b32 v67, 16, v83
    v_and_b32 v83, 0xffff0000, v83
    v_lshlrev_b32 v68, 16, v84
    v_and_b32 v84, 0xffff0000, v84
    v_lshlrev_b32 v69, 16, v85
    v_and_b32 v85, 0xffff0000, v85
k_x_11:
    ds_read_b32 v3, v1 offset:308
    ds_read_b128 v[86:89], v153 offset:0
    ds_read_b128 v[90:93], v153 offset:1024
    ds_read_b128 v[94:97], v153 offset:2048
    ds_read_b128 v[98:101], v153 offset:3072
    s_add_u32 s35, s35, 1
    s_waitcnt lgkmcnt(4)
    v_readfirstlane_b32 s37, v3
    s_cmp_eq_u32 s37, 4
    s_cbranch_scc1 k_x_11_x
    s_cmp_lt_u32 s35, 2097152
    s_cbranch_scc1 k_x_11
k_x_11_x:
    s_waitcnt lgkmcnt(3)
    v_mfma_f32_16x16x32_bf16 v[102:105], v[46:49], v[86:89], 0
    v_mfma_f32_16x16x32_bf16 v[106:109], v[50:53], v[86:89], 0
    s_waitcnt lgkmcnt(2)
    v_mfma_f32_16x16x32_bf16 v[110:113], v[46:49], v[90:93], 0
    v_mfma_f32_16x16x32_bf16 v[114:117], v[50:53], v[90:93], 0
    s_waitcnt lgkmcnt(1)
    v_mfma_f32_16x16x32_bf16 v[118:121], v[46:49], v[94:97], 0
    v_mfma_f32_16x16x32_bf16 v[122:125], v[50:53], v[94:97], 0
    s_waitcnt lgkmcnt(0)
    v_mfma_f32_16x16x32_bf16 v[126:129], v[46:49], v[98:101], 0
    v_mfma_f32_16x16x32_bf16 v[130:133], v[50:53], v[98:101], 0
    v_mul_f32 v134, v106, v70
    v_mul_f32 v135, v106, v54
    v_fma_f32 v134, v102, v54, -v134
    v_fmac_f32 v135, v102, v70
    v_cvt_pk_bf16_f32 v86, v134, -v135
    v_mul_f32 v136, v107, v74
    v_mul_f32 v137, v107, v58
    v_fma_f32 v136, v103, v58, -v136
    v_fmac_f32 v137, v103, v74
    v_cvt_pk_bf16_f32 v87, v136, -v137
    v_mul_f32 v134, v108, v78
    v_mul_f32 v135, v108, v62
    v_fma_f32 v134, v104, v62, -v134
    v_fmac_f32 v135, v104, v78
    v_cvt_pk_bf16_f32 v88, v134, -v135
    v_mul_f32 v136, v109, v82
    v_mul_f32 v137, v109, v66
    v_fma_f32 v136, v105, v66, -v136
    v_fmac_f32 v137, v105, v82
    v_cvt_pk_bf16_f32 v89, v136, -v137
    v_mul_f32 v134, v114, v71
    v_mul_f32 v135, v114, v55
    v_fma_f32 v134, v110, v55, -v134
    v_fmac_f32 v135, v110, v71
    v_cvt_pk_bf16_f32 v90, v134, -v135
    v_mul_f32 v136, v115, v75
    v_mul_f32 v137, v115, v59
    v_fma_f32 v136, v111, v59, -v136
    v_fmac_f32 v137, v111, v75
    v_cvt_pk_bf16_f32 v91, v136, -v137
    v_mul_f32 v134, v116, v79
    v_mul_f32 v135, v116, v63
    v_fma_f32 v134, v112, v63, -v134
    v_fmac_f32 v135, v112, v79
    v_cvt_pk_bf16_f32 v92, v134, -v135
    v_mul_f32 v136, v117, v83
    v_mul_f32 v137, v117, v67
    v_fma_f32 v136, v113, v67, -v136
    v_fmac_f32 v137, v113, v83
    v_cvt_pk_bf16_f32 v93, v136, -v137
    v_mul_f32 v134, v122, v72
    v_mul_f32 v135, v122, v56
    v_fma_f32 v134, v118, v56, -v134
    v_fmac_f32 v135, v118, v72
    v_cvt_pk_bf16_f32 v94, v134, -v135
    v_mul_f32 v136, v123, v76
    v_mul_f32 v137, v123, v60
    v_fma_f32 v136, v119, v60, -v136
    v_fmac_f32 v137, v119, v76
    v_cvt_pk_bf16_f32 v95, v136, -v137
    v_mul_f32 v134, v124, v80
    v_mul_f32 v135, v124, v64
    v_fma_f32 v134, v120, v64, -v134
    v_fmac_f32 v135, v120, v80
    v_cvt_pk_bf16_f32 v96, v134, -v135
    v_mul_f32 v136, v125, v84
    v_mul_f32 v137, v125, v68
    v_fma_f32 v136, v121, v68, -v136
    v_fmac_f32 v137, v121, v84
    v_cvt_pk_bf16_f32 v97, v136, -v137
    v_mul_f32 v134, v130, v73
    v_mul_f32 v135, v130, v57
    v_fma_f32 v134, v126, v57, -v134
    v_fmac_f32 v135, v126, v73
    v_cvt_pk_bf16_f32 v98, v134, -v135
    v_mul_f32 v136, v131, v77
    v_mul_f32 v137, v131, v61
    v_fma_f32 v136, v127, v61, -v136
    v_fmac_f32 v137, v127, v77
    v_cvt_pk_bf16_f32 v99, v136, -v137
    v_mul_f32 v134, v132, v81
    v_mul_f32 v135, v132, v65
    v_fma_f32 v134, v128, v65, -v134
    v_fmac_f32 v135, v128, v81
    v_cvt_pk_bf16_f32 v100, v134, -v135
    v_mul_f32 v136, v133, v85
    v_mul_f32 v137, v133, v69
    v_fma_f32 v136, v129, v69, -v136
    v_fmac_f32 v137, v129, v85
    v_cvt_pk_bf16_f32 v101, v136, -v137
    v_mfma_f32_16x16x32_bf16 v[102:105], v[14:17], v[86:89], 0
    v_mfma_f32_16x16x32_bf16 v[106:109], v[18:21], v[86:89], 0
    v_mfma_f32_16x16x32_bf16 v[110:113], v[22:25], v[90:93], 0
    v_mfma_f32_16x16x32_bf16 v[114:117], v[26:29], v[90:93], 0
    v_mfma_f32_16x16x32_bf16 v[118:121], v[30:33], v[94:97], 0
    v_mfma_f32_16x16x32_bf16 v[122:125], v[34:37], v[94:97], 0
    v_mfma_f32_16x16x32_bf16 v[126:129], v[38:41], v[98:101], 0
    v_mfma_f32_16x16x32_bf16 v[130:133], v[42:45], v[98:101], 0
    s_nop 1
    v_cvt_pk_bf16_f32 v134, v102, v106
    v_cvt_pk_bf16_f32 v138, v103, v107
    v_cvt_pk_bf16_f32 v142, v104, v108
    v_cvt_pk_bf16_f32 v146, v105, v109
    v_cvt_pk_bf16_f32 v135, v110, v114
    v_cvt_pk_bf16_f32 v139, v111, v115
    v_cvt_pk_bf16_f32 v143, v112, v116
    v_cvt_pk_bf16_f32 v147, v113, v117
    v_cvt_pk_bf16_f32 v136, v118, v122
    v_cvt_pk_bf16_f32 v140, v119, v123
    v_cvt_pk_bf16_f32 v144, v120, v124
    v_cvt_pk_bf16_f32 v148, v121, v125
    v_cvt_pk_bf16_f32 v137, v126, v130
    v_cvt_pk_bf16_f32 v141, v127, v131
    v_cvt_pk_bf16_f32 v145, v128, v132
    v_cvt_pk_bf16_f32 v149, v129, v133
    ds_write_b128 v151, v[134:137] offset:16384
    ds_write_b128 v151, v[138:141] offset:17408
    ds_write_b128 v151, v[142:145] offset:18432
    ds_write_b128 v151, v[146:149] offset:19456
    s_mov_b64 exec, 1
    ds_add_u32 v1, v2 offset:312
    s_mov_b64 exec, -1
k_x_13:
    ds_read_b32 v3, v1 offset:312
    ds_read_b128 v[86:89], v153 offset:16384
    ds_read_b128 v[90:93], v153 offset:17408
    ds_read_b128 v[94:97], v153 offset:18432
    ds_read_b128 v[98:101], v153 offset:19456
    s_add_u32 s35, s35, 1
    s_waitcnt lgkmcnt(4)
    v_readfirstlane_b32 s37, v3
    s_cmp_eq_u32 s37, 4
    s_cbranch_scc1 k_x_13_x
    s_cmp_lt_u32 s35, 2097152
    s_cbranch_scc1 k_x_13
k_x_13_x:
    s_waitcnt lgkmcnt(3)
    v_mfma_f32_16x16x32_bf16 v[102:105], v[46:49], v[86:89], 0
    v_mfma_f32_16x16x32_bf16 v[106:109], v[50:53], v[86:89], 0
    s_waitcnt lgkmcnt(2)
    v_mfma_f32_16x16x32_bf16 v[110:113], v[46:49], v[90:93], 0
    v_mfma_f32_16x16x32_bf16 v[114:117], v[50:53], v[90:93], 0
    s_waitcnt lgkmcnt(1)
    v_mfma_f32_16x16x32_bf16 v[118:121], v[46:49], v[94:97], 0
    v_mfma_f32_16x16x32_bf16 v[122:125], v[50:53], v[94:97], 0
    s_waitcnt lgkmcnt(0)
    v_mfma_f32_16x16x32_bf16 v[126:129], v[46:49], v[98:101], 0
    v_mfma_f32_16x16x32_bf16 v[130:133], v[50:53], v[98:101], 0
    v_cvt_pk_bf16_f32 v134, v102, v106
    v_cvt_pk_bf16_f32 v138, v103, v107
    v_cvt_pk_bf16_f32 v142, v104, v108
    v_cvt_pk_bf16_f32 v146, v105, v109
    v_cvt_pk_bf16_f32 v135, v110, v114
    v_cvt_pk_bf16_f32 v139, v111, v115
    v_cvt_pk_bf16_f32 v143, v112, v116
    v_cvt_pk_bf16_f32 v147, v113, v117
    v_cvt_pk_bf16_f32 v136, v118, v122
    v_cvt_pk_bf16_f32 v140, v119, v123
    v_cvt_pk_bf16_f32 v144, v120, v124
    v_cvt_pk_bf16_f32 v148, v121, v125
    v_cvt_pk_bf16_f32 v137, v126, v130
    v_cvt_pk_bf16_f32 v141, v127, v131
    v_cvt_pk_bf16_f32 v145, v128, v132
    v_cvt_pk_bf16_f32 v149, v129, v133
    ds_write2_b32 v156, v134, v135 offset0:0 offset1:16
    ds_write2_b32 v156, v136, v137 offset0:32 offset1:48
    ds_write2_b32 v156, v138, v139 offset0:64 offset1:80
    ds_write2_b32 v156, v140, v141 offset0:96 offset1:112
    ds_write2_b32 v156, v142, v143 offset0:128 offset1:144
    ds_write2_b32 v156, v144, v145 offset0:160 offset1:176
    ds_write2_b32 v156, v146, v147 offset0:192 offset1:208
    ds_write2_b32 v156, v148, v149 offset0:224 offset1:240
    ds_read_b128 v[86:89], v153 offset:0
    ds_read_b128 v[90:93], v153 offset:1024
    ds_read_b128 v[94:97], v153 offset:2048
    ds_read_b128 v[98:101], v153 offset:3072
    s_waitcnt lgkmcnt(3)
    buffer_store_dwordx4 v[86:89], v152, s[16:19], s44 offen sc1
    s_add_u32 s44, s44, 32768
    s_waitcnt lgkmcnt(2)
    buffer_store_dwordx4 v[90:93], v152, s[16:19], s44 offen sc1
    s_add_u32 s44, s44, 32768
    s_waitcnt lgkmcnt(1)
    buffer_store_dwordx4 v[94:97], v152, s[16:19], s44 offen sc1
    s_add_u32 s44, s44, 32768
    s_waitcnt lgkmcnt(0)
    buffer_store_dwordx4 v[98:101], v152, s[16:19], s44 offen sc1
    s_add_u32 s44, s44, 32768
    s_waitcnt vmcnt(0)
    s_mov_b64 exec, 1
    ds_add_rtn_u32 v3, v1, v2 offset:316
    s_mov_b64 exec, -1
    s_waitcnt lgkmcnt(0)
    v_readfirstlane_b32 s37, v3
    s_cmp_lg_u32 s37, 3
    s_cbranch_scc1 k_pub_14
    s_mul_i32 s60, s30, 384
    s_add_u32 s60, s60, 22023168
    s_mov_b32 s61, 1
    s_atomic_add s61, s[82:83], s60 glc
    s_mov_b32 s60, 22130688
    v_mul_u32_u24 v3, 384, v0
    s_waitcnt lgkmcnt(0)
    s_cmp_lg_u32 s61, 20
    s_cbranch_scc1 k_pub_14
    s_mov_b32 exec_hi, 0
    buffer_atomic_add v2, v3, s[16:19], s60 offen sc1
    s_mov_b32 exec_hi, -1
k_pub_14:
    s_branch k_mid2
k_notask:
    s_waitcnt vmcnt(0)
    s_mov_b64 exec, 1
    ds_add_rtn_u32 v3, v1, v2 offset:300
    s_mov_b64 exec, -1
    s_waitcnt lgkmcnt(0)
    v_readfirstlane_b32 s37, v3
    s_cmp_lg_u32 s37, 3
    s_cbranch_scc1 k_pub_15
    s_mov_b32 s62, 1
    s_atomic_add s62, s[82:83], s53 glc
k_pub_15:
    s_cmp_lg_u32 s41, 0
    s_cbranch_scc1 k_mid2
k_s_16:
    s_load_dword s37, s[82:83], s48 glc
    s_add_u32 s35, s35, 1
    s_waitcnt lgkmcnt(0)
    s_cmp_eq_u32 s37, 8
    s_cbranch_scc1 k_s_16_x
    s_sleep 2
    s_cmp_lt_u32 s35, 2097152
    s_cbranch_scc1 k_s_16
k_s_16_x:
k_w_17:
    ds_read_b32 v3, v1 offset:300
    s_waitcnt lgkmcnt(0)
    v_readfirstlane_b32 s37, v3
    s_add_u32 s35, s35, 1
    s_cmp_eq_u32 s37, 4
    s_cbranch_scc1 k_w_17_x
    s_cmp_lt_u32 s35, 2097152
    s_cbranch_scc1 k_w_17
k_w_17_x:
    s_mov_b64 exec, 1
    ds_add_u32 v1, v2 offset:336
    s_mov_b64 exec, -1
k_mid2:
    s_setprio 0
    v_and_b32 v106, 15, v0
    v_cvt_f32_u32 v106, v106
    v_lshrrev_b32 v107, 4, v0
    v_lshlrev_b32 v107, 2, v107
    v_cvt_f32_u32 v107, v107
    v_mul_f32 v121, 0x3d800000, v106
    v_add_f32 v108, 0x00000000, v107
    v_mul_f32 v108, v108, v121
    v_add_f32 v109, v108, v121
    v_add_f32 v110, v109, v121
    v_add_f32 v111, v110, v121
    v_cos_f32 v112, v108
    v_cos_f32 v113, v109
    v_cos_f32 v114, v110
    v_cos_f32 v115, v111
    v_sin_f32 v116, v108
    v_sin_f32 v117, v109
    v_sin_f32 v118, v110
    v_sin_f32 v119, v111
    v_cvt_pk_bf16_f32 v70, v112, v113
    v_cvt_pk_bf16_f32 v71, v114, v115
    v_cvt_pk_bf16_f32 v68, -v116, -v117
    v_cvt_pk_bf16_f32 v72, v116, v117
    v_cvt_pk_bf16_f32 v69, -v118, -v119
    v_cvt_pk_bf16_f32 v73, v118, v119
    v_add_f32 v120, 0x00000000, v106
    v_mul_f32 v121, 0x3ccccccd, v120
    v_add_f32 v108, 0x00000000, v107
    v_mul_f32 v108, v108, v121
    v_add_f32 v109, v108, v121
    v_add_f32 v110, v109, v121
    v_add_f32 v111, v110, v121
    v_cos_f32 v112, v108
    v_cos_f32 v113, v109
    v_cos_f32 v114, v110
    v_cos_f32 v115, v111
    v_sin_f32 v116, v108
    v_sin_f32 v117, v109
    v_sin_f32 v118, v110
    v_sin_f32 v119, v111
    v_cvt_pk_bf16_f32 v16, v112, v113
    v_cvt_pk_bf16_f32 v17, v114, v115
    v_cvt_pk_bf16_f32 v14, -v116, -v117
    v_cvt_pk_bf16_f32 v18, v116, v117
    v_cvt_pk_bf16_f32 v15, -v118, -v119
    v_cvt_pk_bf16_f32 v19, v118, v119
    v_add_f32 v108, 0x41800000, v107
    v_mul_f32 v108, v108, v121
    v_add_f32 v109, v108, v121
    v_add_f32 v110, v109, v121
    v_add_f32 v111, v110, v121
    v_cos_f32 v112, v108
    v_cos_f32 v113, v109
    v_cos_f32 v114, v110
    v_cos_f32 v115, v111
    v_sin_f32 v116, v108
    v_sin_f32 v117, v109
    v_sin_f32 v118, v110
    v_sin_f32 v119, v111
    v_cvt_pk_bf16_f32 v22, v112, v113
    v_cvt_pk_bf16_f32 v23, v114, v115
    v_cvt_pk_bf16_f32 v20, -v116, -v117
    v_cvt_pk_bf16_f32 v24, v116, v117
    v_cvt_pk_bf16_f32 v21, -v118, -v119
    v_cvt_pk_bf16_f32 v25, v118, v119
    v_mov_b32 v26, 0
    v_mov_b32 v27, 0
    v_mov_b32 v28, 0
    v_mov_b32 v29, 0
    v_mov_b32 v30, 0
    v_mov_b32 v31, 0
    s_mov_b32 exec_hi, 0
    v_add_f32 v108, 0x42000000, v107
    v_mul_f32 v108, v108, v121
    v_add_f32 v109, v108, v121
    v_add_f32 v110, v109, v121
    v_add_f32 v111, v110, v121
    v_cos_f32 v112, v108
    v_cos_f32 v113, v109
    v_cos_f32 v114, v110
    v_cos_f32 v115, v111
    v_sin_f32 v116, v108
    v_sin_f32 v117, v109
    v_sin_f32 v118, v110
    v_sin_f32 v119, v111
    v_cvt_pk_bf16_f32 v28, v112, v113
    v_cvt_pk_bf16_f32 v29, v114, v115
    v_cvt_pk_bf16_f32 v26, -v116, -v117
    v_cvt_pk_bf16_f32 v30, v116, v117
    v_cvt_pk_bf16_f32 v27, -v118, -v119
    v_cvt_pk_bf16_f32 v31, v118, v119
    s_mov_b32 exec_hi, -1
    v_mul_f32 v121, 0x3acccccd, v120
    v_add_f32 v108, 0x00000000, v107
    v_mul_f32 v108, v108, v121
    v_add_f32 v109, v108, v121
    v_add_f32 v110, v109, v121
    v_add_f32 v111, v110, v121
    v_cos_f32 v74, v108
    v_cos_f32 v75, v109
    v_cos_f32 v76, v110
    v_cos_f32 v77, v111
    v_sin_f32 v86, v108
    v_sin_f32 v87, v109
    v_sin_f32 v88, v110
    v_sin_f32 v89, v111
    v_add_f32 v120, 0x41800000, v106
    v_mul_f32 v121, 0x3ccccccd, v120
    v_add_f32 v108, 0x00000000, v107
    v_mul_f32 v108, v108, v121
    v_add_f32 v109, v108, v121
    v_add_f32 v110, v109, v121
    v_add_f32 v111, v110, v121
    v_cos_f32 v112, v108
    v_cos_f32 v113, v109
    v_cos_f32 v114, v110
    v_cos_f32 v115, v111
    v_sin_f32 v116, v108
    v_sin_f32 v117, v109
    v_sin_f32 v118, v110
    v_sin_f32 v119, v111
    v_cvt_pk_bf16_f32 v34, v112, v113
    v_cvt_pk_bf16_f32 v35, v114, v115
    v_cvt_pk_bf16_f32 v32, -v116, -v117
    v_cvt_pk_bf16_f32 v36, v116, v117
    v_cvt_pk_bf16_f32 v33, -v118, -v119
    v_cvt_pk_bf16_f32 v37, v118, v119
    v_add_f32 v108, 0x41800000, v107
    v_mul_f32 v108, v108, v121
    v_add_f32 v109, v108, v121
    v_add_f32 v110, v109, v121
    v_add_f32 v111, v110, v121
    v_cos_f32 v112, v108
    v_cos_f32 v113, v109
    v_cos_f32 v114, v110
    v_cos_f32 v115, v111
    v_sin_f32 v116, v108
    v_sin_f32 v117, v109
    v_sin_f32 v118, v110
    v_sin_f32 v119, v111
    v_cvt_pk_bf16_f32 v40, v112, v113
    v_cvt_pk_bf16_f32 v41, v114, v115
    v_cvt_pk_bf16_f32 v38, -v116, -v117
    v_cvt_pk_bf16_f32 v42, v116, v117
    v_cvt_pk_bf16_f32 v39, -v118, -v119
    v_cvt_pk_bf16_f32 v43, v118, v119
    v_mov_b32 v44, 0
    v_mov_b32 v45, 0
    v_mov_b32 v46, 0
    v_mov_b32 v47, 0
    v_mov_b32 v48, 0
    v_mov_b32 v49, 0
    s_mov_b32 exec_hi, 0
    v_add_f32 v108, 0x42000000, v107
    v_mul_f32 v108, v108, v121
    v_add_f32 v109, v108, v121
    v_add_f32 v110, v109, v121
    v_add_f32 v111, v110, v121
    v_cos_f32 v112, v108
    v_cos_f32 v113, v109
    v_cos_f32 v114, v110
    v_cos_f32 v115, v111
    v_sin_f32 v116, v108
    v_sin_f32 v117, v109
    v_sin_f32 v118, v110
    v_sin_f32 v119, v111
    v_cvt_pk_bf16_f32 v46, v112, v113
    v_cvt_pk_bf16_f32 v47, v114, v115
    v_cvt_pk_bf16_f32 v44, -v116, -v117
    v_cvt_pk_bf16_f32 v48, v116, v117
    v_cvt_pk_bf16_f32 v45, -v118, -v119
    v_cvt_pk_bf16_f32 v49, v118, v119
    s_mov_b32 exec_hi, -1
    v_mul_f32 v121, 0x3acccccd, v120
    v_add_f32 v108, 0x00000000, v107
    v_mul_f32 v108, v108, v121
    v_add_f32 v109, v108, v121
    v_add_f32 v110, v109, v121
    v_add_f32 v111, v110, v121
    v_cos_f32 v78, v108
    v_cos_f32 v79, v109
    v_cos_f32 v80, v110
    v_cos_f32 v81, v111
    v_sin_f32 v90, v108
    v_sin_f32 v91, v109
    v_sin_f32 v92, v110
    v_sin_f32 v93, v111
    v_add_f32 v120, 0x42000000, v106
    v_mul_f32 v121, 0x3ccccccd, v120
    v_add_f32 v108, 0x00000000, v107
    v_mul_f32 v108, v108, v121
    v_add_f32 v109, v108, v121
    v_add_f32 v110, v109, v121
    v_add_f32 v111, v110, v121
    v_cos_f32 v112, v108
    v_cos_f32 v113, v109
    v_cos_f32 v114, v110
    v_cos_f32 v115, v111
    v_sin_f32 v116, v108
    v_sin_f32 v117, v109
    v_sin_f32 v118, v110
    v_sin_f32 v119, v111
    v_cvt_pk_bf16_f32 v52, v112, v113
    v_cvt_pk_bf16_f32 v53, v114, v115
    v_cvt_pk_bf16_f32 v50, -v116, -v117
    v_cvt_pk_bf16_f32 v54, v116, v117
    v_cvt_pk_bf16_f32 v51, -v118, -v119
    v_cvt_pk_bf16_f32 v55, v118, v119
    v_add_f32 v108, 0x41800000, v107
    v_mul_f32 v108, v108, v121
    v_add_f32 v109, v108, v121
    v_add_f32 v110, v109, v121
    v_add_f32 v111, v110, v121
    v_cos_f32 v112, v108
    v_cos_f32 v113, v109
    v_cos_f32 v114, v110
    v_cos_f32 v115, v111
    v_sin_f32 v116, v108
    v_sin_f32 v117, v109
    v_sin_f32 v118, v110
    v_sin_f32 v119, v111
    v_cvt_pk_bf16_f32 v58, v112, v113
    v_cvt_pk_bf16_f32 v59, v114, v115
    v_cvt_pk_bf16_f32 v56, -v116, -v117
    v_cvt_pk_bf16_f32 v60, v116, v117
    v_cvt_pk_bf16_f32 v57, -v118, -v119
    v_cvt_pk_bf16_f32 v61, v118, v119
    v_mov_b32 v62, 0
    v_mov_b32 v63, 0
    v_mov_b32 v64, 0
    v_mov_b32 v65, 0
    v_mov_b32 v66, 0
    v_mov_b32 v67, 0
    s_mov_b32 exec_hi, 0
    v_add_f32 v108, 0x42000000, v107
    v_mul_f32 v108, v108, v121
    v_add_f32 v109, v108, v121
    v_add_f32 v110, v109, v121
    v_add_f32 v111, v110, v121
    v_cos_f32 v112, v108
    v_cos_f32 v113, v109
    v_cos_f32 v114, v110
    v_cos_f32 v115, v111
    v_sin_f32 v116, v108
    v_sin_f32 v117, v109
    v_sin_f32 v118, v110
    v_sin_f32 v119, v111
    v_cvt_pk_bf16_f32 v64, v112, v113
    v_cvt_pk_bf16_f32 v65, v114, v115
    v_cvt_pk_bf16_f32 v62, -v116, -v117
    v_cvt_pk_bf16_f32 v66, v116, v117
    v_cvt_pk_bf16_f32 v63, -v118, -v119
    v_cvt_pk_bf16_f32 v67, v118, v119
    s_mov_b32 exec_hi, -1
    v_mul_f32 v121, 0x3acccccd, v120
    v_add_f32 v108, 0x00000000, v107
    v_mul_f32 v108, v108, v121
    v_add_f32 v109, v108, v121
    v_add_f32 v110, v109, v121
    v_add_f32 v111, v110, v121
    v_cos_f32 v82, v108
    v_cos_f32 v83, v109
    v_cos_f32 v84, v110
    v_cos_f32 v85, v111
    v_sin_f32 v94, v108
    v_sin_f32 v95, v109
    v_sin_f32 v96, v110
    v_sin_f32 v97, v111
    v_mul_f32 v74, 0x354ccccd, v74
    v_mul_f32 v75, 0x354ccccd, v75
    v_mul_f32 v76, 0x354ccccd, v76
    v_mul_f32 v77, 0x354ccccd, v77
    v_mul_f32 v78, 0x354ccccd, v78
    v_mul_f32 v79, 0x354ccccd, v79
    v_mul_f32 v80, 0x354ccccd, v80
    v_mul_f32 v81, 0x354ccccd, v81
    v_mul_f32 v82, 0x354ccccd, v82
    v_mul_f32 v83, 0x354ccccd, v83
    v_mul_f32 v84, 0x354ccccd, v84
    v_mul_f32 v85, 0x354ccccd, v85
    v_mul_f32 v86, 0x354ccccd, v86
    v_mul_f32 v87, 0x354ccccd, v87
    v_mul_f32 v88, 0x354ccccd, v88
    v_mul_f32 v89, 0x354ccccd, v89
    v_mul_f32 v90, 0x354ccccd, v90
    v_mul_f32 v91, 0x354ccccd, v91
    v_mul_f32 v92, 0x354ccccd, v92
    v_mul_f32 v93, 0x354ccccd, v93
    v_mul_f32 v94, 0x354ccccd, v94
    v_mul_f32 v95, 0x354ccccd, v95
    v_mul_f32 v96, 0x354ccccd, v96
    v_mul_f32 v97, 0x354ccccd, v97
    v_bfe_u32 v106, v0, 2, 2
    v_lshlrev_b32 v106, 8, v106
    v_add_u32 v106, s34, v106
    v_cvt_f32_u32 v106, v106
    v_bfe_u32 v107, v0, 1, 1
    v_lshrrev_b32 v108, 5, v0
    v_cmp_eq_u32 vcc, v107, v108
    v_mov_b32 v109, 0x3fb504f3
    s_nop 0
    v_cndmask_b32 v109, 0, v109, vcc
    v_cvt_f32_u32 v107, v107
    v_mov_b32 v110, -1.0
    v_fmac_f32 v110, 2.0, v107
    v_mul_f32 v106, v106, v110
    v_mul_f32 v106, 0x3a000000, v106
    v_bfe_u32 v111, v0, 4, 1
    v_lshlrev_b32 v111, 2, v111
    v_cvt_f32_u32 v111, v111
    v_mul_f32 v111, v111, v106
    v_mul_f32 v110, v110, v109
    v_and_b32 v112, 1, v0
    v_cmp_eq_u32 vcc, 1, v112
    v_add_f32 v113, 0xbe000000, v111
    v_cos_f32 v114, v113
    v_sin_f32 v115, v113
    v_add_f32 v111, v111, v106
    v_cndmask_b32 v116, v114, v115, vcc
    v_sub_f32 v114, 0, v114
    v_cndmask_b32 v117, v115, v114, vcc
    v_mul_f32 v116, v116, v109
    v_mul_f32 v117, v117, v110
    v_cvt_pk_bf16_f32 v98, v116, v117
    v_add_f32 v113, 0x3e000000, v111
    v_cos_f32 v114, v113
    v_sin_f32 v115, v113
    v_add_f32 v111, v111, v106
    v_cndmask_b32 v116, v114, v115, vcc
    v_sub_f32 v114, 0, v114
    v_cndmask_b32 v117, v115, v114, vcc
    v_mul_f32 v116, v116, v109
    v_mul_f32 v117, v117, v110
    v_cvt_pk_bf16_f32 v99, v116, v117
    v_add_f32 v113, 0xbe000000, v111
    v_cos_f32 v114, v113
    v_sin_f32 v115, v113
    v_add_f32 v111, v111, v106
    v_cndmask_b32 v116, v114, v115, vcc
    v_sub_f32 v114, 0, v114
    v_cndmask_b32 v117, v115, v114, vcc
    v_mul_f32 v116, v116, v109
    v_mul_f32 v117, v117, v110
    v_cvt_pk_bf16_f32 v100, v116, v117
    v_add_f32 v113, 0x3e000000, v111
    v_cos_f32 v114, v113
    v_sin_f32 v115, v113
    v_add_f32 v111, v111, v106
    v_cndmask_b32 v116, v114, v115, vcc
    v_sub_f32 v114, 0, v114
    v_cndmask_b32 v117, v115, v114, vcc
    v_mul_f32 v116, v116, v109
    v_mul_f32 v117, v117, v110
    v_cvt_pk_bf16_f32 v101, v116, v117
    s_mul_i32 s37, s41, 2592
    s_add_u32 s37, s37, 123392
    v_lshl_add_u32 v152, v0, 3, s37
    v_and_b32 v153, 31, v0
    v_lshl_add_u32 v153, v153, 3, s37
    v_and_b32 v106, 15, v0
    v_xor_b32 v107, 3, v106
    v_add_u32 v107, 1, v107
    v_cmp_gt_u32 vcc, 32, v0
    s_nop 1
    v_cndmask_b32 v106, v107, v106, vcc
    v_lshrrev_b32 v107, 4, v106
    v_and_b32 v106, 15, v106
    v_lshlrev_b32 v107, 9, v107
    v_lshl_add_u32 v106, v106, 2, v107
    v_bfe_u32 v107, v0, 4, 1
    v_lshl_add_u32 v106, v107, 8, v106
    s_mul_i32 s45, s41, 5120
    s_add_u32 s45, s45, 133760
    v_add_u32 v154, s45, v106
    v_lshrrev_b32 v106, 5, v0
    v_lshlrev_b32 v106, 17, v106
    v_lshl_add_u32 v164, v162, 4, v106
    s_lshl_b32 s43, s34, 9
    s_lshl_b32 s38, s41, 17
    s_add_u32 s43, s43, s38
    s_add_u32 s43, s43, 3145728
    v_bfe_u32 v106, v0, 2, 2
    v_mul_u32_u24 v106, 2592, v106
    v_and_b32 v107, 1, v0
    v_mul_u32_u24 v107, 1296, v107
    v_add_u32 v106, v106, v107
    v_lshrrev_b32 v107, 4, v0
    v_lshlrev_b32 v107, 3, v107
    s_lshl_b32 s38, s41, 5
    v_add_u32 v107, s38, v107
    v_sub_u32 v108, 760, v107
    v_and_b32 v109, 2, v0
    v_cmp_eq_u32 vcc, 2, v109
    s_nop 1
    v_cndmask_b32 v107, v107, v108, vcc
    v_add3_u32 v155, v106, v107, s37
    s_mul_i32 s38, s41, 2592
    v_subrev_u32 v155, s38, v155
    v_add_u32 v156, 512, v155
    v_cndmask_b32 v156, v155, v156, vcc
    v_mov_b32 v106, 128
    v_mov_b32 v107, -128
    v_cndmask_b32 v157, v106, v107, vcc
    v_and_b32 v106, 15, v0
    v_mul_u32_u24 v106, 80, v106
    v_lshrrev_b32 v107, 4, v0
    v_lshl_add_u32 v106, v107, 3, v106
    s_mul_i32 s37, s41, 2560
    s_add_u32 s37, s37, 133760
    v_add_u32 v158, s37, v106
    v_lshrrev_b32 v159, 5, v0
    v_mul_u32_u24 v159, 1280, v159
    v_add_u32 v159, s37, v159
    v_lshl_add_u32 v163, v162, 3, v159
    v_lshl_add_u32 v159, v162, 4, v159
    s_setprio 3
    s_cmp_lg_u32 s41, 0
    s_cbranch_scc1 k_p3go
    s_mul_i32 s46, s31, 384
    s_add_u32 s46, s46, 22130688
k_s_18:
    s_load_dword s37, s[82:83], s46 glc
    s_add_u32 s35, s35, 1
    s_waitcnt lgkmcnt(0)
    s_cmp_eq_u32 s37, 8
    s_cbranch_scc1 k_s_18_x
    s_sleep 2
    s_cmp_lt_u32 s35, 2097152
    s_cbranch_scc1 k_s_18
k_s_18_x:
k_p3go:
    s_waitcnt lgkmcnt(0)
    s_mov_b64 exec, 1
    ds_add_u32 v1, v2 offset:320
    s_mov_b64 exec, -1
k_w_19:
    ds_read_b32 v3, v1 offset:320
    s_waitcnt lgkmcnt(0)
    v_readfirstlane_b32 s37, v3
    s_add_u32 s35, s35, 1
    s_cmp_eq_u32 s37, 4
    s_cbranch_scc1 k_w_19_x
    s_sleep 1
    s_cmp_lt_u32 s35, 2097152
    s_cbranch_scc1 k_w_19
k_w_19_x:
    s_add_u32 m0, s45, 0
    s_nop 0
    buffer_load_dwordx4 v164, s[16:19], s43 offen sc1 lds
    s_add_u32 s43, s43, 524288
    s_add_u32 m0, s45, 1024
    s_nop 0
    buffer_load_dwordx4 v164, s[16:19], s43 offen sc1 lds
    s_add_u32 s43, s43, 524288
    s_add_u32 m0, s45, 2048
    s_nop 0
    buffer_load_dwordx4 v164, s[16:19], s43 offen sc1 lds
    s_add_u32 s43, s43, 524288
    s_add_u32 m0, s45, 3072
    s_nop 0
    buffer_load_dwordx4 v164, s[16:19], s43 offen sc1 lds
    s_add_u32 s43, s43, 524288
    s_add_u32 m0, s45, 4096
    s_nop 0
    buffer_load_dwordx4 v164, s[16:19], s43 offen sc1 lds
    s_add_u32 s43, s43, 524288
    s_waitcnt vmcnt(4)
    ds_read_b32 v106, v154 offset:0
    ds_read_b32 v107, v154 offset:64
    ds_read_b32 v108, v154 offset:128
    ds_read_b32 v109, v154 offset:192
    s_waitcnt vmcnt(3)
    ds_read_b32 v110, v154 offset:1024
    ds_read_b32 v111, v154 offset:1088
    ds_read_b32 v112, v154 offset:1152
    ds_read_b32 v113, v154 offset:1216
    s_waitcnt vmcnt(2)
    ds_read_b32 v114, v154 offset:2048
    ds_read_b32 v115, v154 offset:2112
    ds_read_b32 v116, v154 offset:2176
    ds_read_b32 v117, v154 offset:2240
    s_waitcnt vmcnt(1)
    ds_read_b32 v118, v154 offset:3072
    ds_read_b32 v119, v154 offset:3136
    ds_read_b32 v120, v154 offset:3200
    ds_read_b32 v121, v154 offset:3264
    s_waitcnt vmcnt(0)
    ds_read_b32 v122, v154 offset:4096
    ds_read_b32 v123, v154 offset:4160
    ds_read_b32 v124, v154 offset:4224
    ds_read_b32 v125, v154 offset:4288
    s_waitcnt lgkmcnt(15)
    v_mfma_f32_16x16x32_bf16 v[126:129], v[106:109], v[98:101], 0
    s_waitcnt lgkmcnt(12)
    v_mfma_f32_16x16x32_bf16 v[130:133], v[110:113], v[98:101], 0
    s_waitcnt lgkmcnt(8)
    v_mfma_f32_16x16x32_bf16 v[134:137], v[114:117], v[98:101], 0
    s_waitcnt lgkmcnt(4)
    v_mfma_f32_16x16x32_bf16 v[138:141], v[118:121], v[98:101], 0
    s_waitcnt lgkmcnt(0)
    v_mfma_f32_16x16x32_bf16 v[142:145], v[122:125], v[98:101], 0
    v_cvt_pk_bf16_f32 v106, v126, v127
    v_cvt_pk_bf16_f32 v107, v128, v129
    ds_write_b64 v156, v[106:107]
    v_add_u32 v156, v156, v157
    v_cvt_pk_bf16_f32 v108, v130, v131
    v_cvt_pk_bf16_f32 v109, v132, v133
    ds_write_b64 v156, v[108:109]
    v_add_u32 v156, v156, v157
    v_cvt_pk_bf16_f32 v110, v134, v135
    v_cvt_pk_bf16_f32 v111, v136, v137
    ds_write_b64 v156, v[110:111]
    v_add_u32 v156, v156, v157
    v_cvt_pk_bf16_f32 v112, v138, v139
    v_cvt_pk_bf16_f32 v113, v140, v141
    ds_write_b64 v156, v[112:113]
    v_add_u32 v156, v156, v157
    v_cvt_pk_bf16_f32 v114, v142, v143
    v_cvt_pk_bf16_f32 v115, v144, v145
    ds_write_b64 v156, v[114:115]
    s_mov_b64 exec, 1
    ds_add_u32 v1, v2 offset:324
    s_mov_b64 exec, -1
k_x_21:
    ds_read_b32 v3, v1 offset:324
    ds_read_b64_tr_b16 v[140:141], v152 offset:0
    ds_read_b64_tr_b16 v[142:143], v152 offset:1296
    ds_read_b64_tr_b16 v[144:145], v152 offset:512
    ds_read_b64_tr_b16 v[146:147], v152 offset:1808
    ds_read_b64_tr_b16 v[148:149], v153 offset:1024
    ds_read_b64_tr_b16 v[150:151], v153 offset:2320
    s_add_u32 s35, s35, 1
    s_waitcnt lgkmcnt(6)
    v_readfirstlane_b32 s37, v3
    s_cmp_eq_u32 s37, 4
    s_cbranch_scc1 k_x_21_x
    s_cmp_lt_u32 s35, 2097152
    s_cbranch_scc1 k_x_21
k_x_21_x:
    s_waitcnt lgkmcnt(4)
    v_mfma_f32_16x16x32_bf16 v[106:109], v[140:143], v[16:19], 0
    v_mfma_f32_16x16x32_bf16 v[110:113], v[140:143], v[14:17], 0
    v_mfma_f32_16x16x32_bf16 v[114:117], v[140:143], v[34:37], 0
    v_mfma_f32_16x16x32_bf16 v[118:121], v[140:143], v[32:35], 0
    v_mfma_f32_16x16x32_bf16 v[122:125], v[140:143], v[52:55], 0
    v_mfma_f32_16x16x32_bf16 v[126:129], v[140:143], v[50:53], 0
    s_waitcnt lgkmcnt(2)
    v_mfma_f32_16x16x32_bf16 v[106:109], v[144:147], v[22:25], v[106:109]
    v_mfma_f32_16x16x32_bf16 v[110:113], v[144:147], v[20:23], v[110:113]
    v_mfma_f32_16x16x32_bf16 v[114:117], v[144:147], v[40:43], v[114:117]
    v_mfma_f32_16x16x32_bf16 v[118:121], v[144:147], v[38:41], v[118:121]
    v_mfma_f32_16x16x32_bf16 v[122:125], v[144:147], v[58:61], v[122:125]
    v_mfma_f32_16x16x32_bf16 v[126:129], v[144:147], v[56:59], v[126:129]
    s_waitcnt lgkmcnt(0)
    v_mfma_f32_16x16x32_bf16 v[106:109], v[148:151], v[28:31], v[106:109]
    v_mfma_f32_16x16x32_bf16 v[110:113], v[148:151], v[26:29], v[110:113]
    v_mfma_f32_16x16x32_bf16 v[114:117], v[148:151], v[46:49], v[114:117]
    v_mfma_f32_16x16x32_bf16 v[118:121], v[148:151], v[44:47], v[118:121]
    v_mfma_f32_16x16x32_bf16 v[122:125], v[148:151], v[64:67], v[122:125]
    v_mfma_f32_16x16x32_bf16 v[126:129], v[148:151], v[62:65], v[126:129]
    s_nop 2
    v_mul_f32 v130, v106, v74
    v_mul_f32 v134, v110, v74
    v_fmac_f32 v130, v110, v86
    v_fma_f32 v134, -v106, v86, v134
    v_mul_f32 v131, v107, v75
    v_mul_f32 v135, v111, v75
    v_fmac_f32 v131, v111, v87
    v_fma_f32 v135, -v107, v87, v135
    v_mul_f32 v132, v108, v76
    v_mul_f32 v136, v112, v76
    v_fmac_f32 v132, v112, v88
    v_fma_f32 v136, -v108, v88, v136
    v_mul_f32 v133, v109, v77
    v_mul_f32 v137, v113, v77
    v_fmac_f32 v133, v113, v89
    v_fma_f32 v137, -v109, v89, v137
    v_cvt_pk_bf16_f32 v140, v130, v131
    v_cvt_pk_bf16_f32 v141, v132, v133
    v_cvt_pk_bf16_f32 v142, v134, v135
    v_cvt_pk_bf16_f32 v143, v136, v137
    v_mul_f32 v130, v114, v78
    v_mul_f32 v134, v118, v78
    v_fmac_f32 v130, v118, v90
    v_fma_f32 v134, -v114, v90, v134
    v_mul_f32 v131, v115, v79
    v_mul_f32 v135, v119, v79
    v_fmac_f32 v131, v119, v91
    v_fma_f32 v135, -v115, v91, v135
    v_mul_f32 v132, v116, v80
    v_mul_f32 v136, v120, v80
    v_fmac_f32 v132, v120, v92
    v_fma_f32 v136, -v116, v92, v136
    v_mul_f32 v133, v117, v81
    v_mul_f32 v137, v121, v81
    v_fmac_f32 v133, v121, v93
    v_fma_f32 v137, -v117, v93, v137
    v_cvt_pk_bf16_f32 v144, v130, v131
    v_cvt_pk_bf16_f32 v145, v132, v133
    v_cvt_pk_bf16_f32 v146, v134, v135
    v_cvt_pk_bf16_f32 v147, v136, v137
    v_mul_f32 v130, v122, v82
    v_mul_f32 v134, v126, v82
    v_fmac_f32 v130, v126, v94
    v_fma_f32 v134, -v122, v94, v134
    v_mul_f32 v131, v123, v83
    v_mul_f32 v135, v127, v83
    v_fmac_f32 v131, v127, v95
    v_fma_f32 v135, -v123, v95, v135
    v_mul_f32 v132, v124, v84
    v_mul_f32 v136, v128, v84
    v_fmac_f32 v132, v128, v96
    v_fma_f32 v136, -v124, v96, v136
    v_mul_f32 v133, v125, v85
    v_mul_f32 v137, v129, v85
    v_fmac_f32 v133, v129, v97
    v_fma_f32 v137, -v125, v97, v137
    v_cvt_pk_bf16_f32 v148, v130, v131
    v_cvt_pk_bf16_f32 v149, v132, v133
    v_cvt_pk_bf16_f32 v150, v134, v135
    v_cvt_pk_bf16_f32 v151, v136, v137
    v_mfma_f32_16x16x32_bf16 v[106:109], v[140:143], v[70:73], 0
    v_mfma_f32_16x16x32_bf16 v[110:113], v[140:143], v[68:71], 0
    v_mfma_f32_16x16x32_bf16 v[114:117], v[144:147], v[70:73], 0
    v_mfma_f32_16x16x32_bf16 v[118:121], v[144:147], v[68:71], 0
    v_mfma_f32_16x16x32_bf16 v[122:125], v[148:151], v[70:73], 0
    v_mfma_f32_16x16x32_bf16 v[126:129], v[148:151], v[68:71], 0
    s_nop 2
    v_cvt_pk_bf16_f32 v130, v106, v107
    v_cvt_pk_bf16_f32 v131, v108, v109
    v_cvt_pk_bf16_f32 v132, -v110, -v111
    v_cvt_pk_bf16_f32 v133, -v112, -v113
    ds_write_b64 v158, v[130:131] offset:0
    ds_write_b64 v158, v[132:133] offset:1280
    v_cvt_pk_bf16_f32 v134, v114, v115
    v_cvt_pk_bf16_f32 v135, v116, v117
    v_cvt_pk_bf16_f32 v136, -v118, -v119
    v_cvt_pk_bf16_f32 v137, -v120, -v121
    ds_write_b64 v158, v[134:135] offset:32
    ds_write_b64 v158, v[136:137] offset:1312
    v_cvt_pk_bf16_f32 v138, v122, v123
    v_cvt_pk_bf16_f32 v139, v124, v125
    v_cvt_pk_bf16_f32 v140, -v126, -v127
    v_cvt_pk_bf16_f32 v141, -v128, -v129
    s_mov_b32 exec_hi, 0
    ds_write_b64 v158, v[138:139] offset:64
    ds_write_b64 v158, v[140:141] offset:1344
    s_mov_b32 exec_hi, -1
    ds_read_b128 v[106:109], v159
    ds_read_b128 v[110:113], v159 offset:512
    ds_read_b64 v[114:115], v163 offset:1024
    s_waitcnt vmcnt(0) lgkmcnt(0)
    v_lshlrev_b32 v116, 16, v106
    v_and_b32 v117, 0xffff0000, v106
    v_lshlrev_b32 v118, 16, v4
    v_and_b32 v119, 0xffff0000, v4
    v_add_f32 v116, v116, v118
    v_add_f32 v117, v117, v119
    v_cvt_pk_bf16_f32 v120, v116, v117
    v_lshlrev_b32 v116, 16, v107
    v_and_b32 v117, 0xffff0000, v107
    v_lshlrev_b32 v118, 16, v5
    v_and_b32 v119, 0xffff0000, v5
    v_add_f32 v116, v116, v118
    v_add_f32 v117, v117, v119
    v_cvt_pk_bf16_f32 v121, v116, v117
    v_lshlrev_b32 v116, 16, v108
    v_and_b32 v117, 0xffff0000, v108
    v_lshlrev_b32 v118, 16, v6
    v_and_b32 v119, 0xffff0000, v6
    v_add_f32 v116, v116, v118
    v_add_f32 v117, v117, v119
    v_cvt_pk_bf16_f32 v122, v116, v117
    v_lshlrev_b32 v116, 16, v109
    v_and_b32 v117, 0xffff0000, v109
    v_lshlrev_b32 v118, 16, v7
    v_and_b32 v119, 0xffff0000, v7
    v_add_f32 v116, v116, v118
    v_add_f32 v117, v117, v119
    v_cvt_pk_bf16_f32 v123, v116, v117
    v_lshlrev_b32 v116, 16, v110
    v_and_b32 v117, 0xffff0000, v110
    v_lshlrev_b32 v118, 16, v8
    v_and_b32 v119, 0xffff0000, v8
    v_add_f32 v116, v116, v118
    v_add_f32 v117, v117, v119
    v_cvt_pk_bf16_f32 v124, v116, v117
    v_lshlrev_b32 v116, 16, v111
    v_and_b32 v117, 0xffff0000, v111
    v_lshlrev_b32 v118, 16, v9
    v_and_b32 v119, 0xffff0000, v9
    v_add_f32 v116, v116, v118
    v_add_f32 v117, v117, v119
    v_cvt_pk_bf16_f32 v125, v116, v117
    v_lshlrev_b32 v116, 16, v112
    v_and_b32 v117, 0xffff0000, v112
    v_lshlrev_b32 v118, 16, v10
    v_and_b32 v119, 0xffff0000, v10
    v_add_f32 v116, v116, v118
    v_add_f32 v117, v117, v119
    v_cvt_pk_bf16_f32 v126, v116, v117
    v_lshlrev_b32 v116, 16, v113
    v_and_b32 v117, 0xffff0000, v113
    v_lshlrev_b32 v118, 16, v11
    v_and_b32 v119, 0xffff0000, v11
    v_add_f32 v116, v116, v118
    v_add_f32 v117, v117, v119
    v_cvt_pk_bf16_f32 v127, v116, v117
    v_lshlrev_b32 v116, 16, v114
    v_and_b32 v117, 0xffff0000, v114
    v_lshlrev_b32 v118, 16, v12
    v_and_b32 v119, 0xffff0000, v12
    v_add_f32 v116, v116, v118
    v_add_f32 v117, v117, v119
    v_cvt_pk_bf16_f32 v128, v116, v117
    v_lshlrev_b32 v116, 16, v115
    v_and_b32 v117, 0xffff0000, v115
    v_lshlrev_b32 v118, 16, v13
    v_and_b32 v119, 0xffff0000, v13
    v_add_f32 v116, v116, v118
    v_add_f32 v117, v117, v119
    v_cvt_pk_bf16_f32 v129, v116, v117
    s_mov_b32 s37, 14680064
    buffer_store_dwordx4 v[120:123], v160, s[16:19], s37 offen sc1
    buffer_store_dwordx4 v[124:127], v160, s[16:19], s37 offen offset:512 sc1
    buffer_store_dwordx2 v[128:129], v161, s[16:19], s37 offen offset:1024 sc1
    s_lshr_b32 s46, s34, 4
    s_mul_i32 s46, s46, 384
    s_add_u32 s46, s46, 22032384
    s_waitcnt vmcnt(0)
    s_mov_b64 exec, 1
    ds_add_rtn_u32 v3, v1, v2 offset:328
    s_mov_b64 exec, -1
    s_waitcnt lgkmcnt(0)
    v_readfirstlane_b32 s37, v3
    s_cmp_lg_u32 s37, 3
    s_cbranch_scc1 k_pub_22
    s_mov_b32 s62, 1
    s_atomic_add s62, s[82:83], s46 glc
k_pub_22:
    s_cmp_lg_u32 s41, 0
    s_cbranch_scc1 k_xaw
    s_mul_i32 s46, s28, 384
    s_add_u32 s46, s46, 22032384
k_s_23:
    s_load_dword s37, s[82:83], s46 glc
    s_add_u32 s35, s35, 1
    s_waitcnt lgkmcnt(0)
    s_cmp_eq_u32 s37, 16
    s_cbranch_scc1 k_s_23_x
    s_sleep 2
    s_cmp_lt_u32 s35, 2097152
    s_cbranch_scc1 k_s_23
k_s_23_x:
    s_mov_b64 exec, 1
    ds_add_u32 v1, v2 offset:284
    s_mov_b64 exec, -1
    s_waitcnt lgkmcnt(0)
k_xaw:
    s_branch k_fin
k_Lr2:
    s_add_u32 m0, s43, 8192
    s_nop 0
    buffer_load_dwordx4 v8, s[8:11], s46 offen lds
    s_waitcnt vmcnt(6)
    s_add_u32 m0, s43, 9216
    s_nop 0
    buffer_load_dwordx4 v9, s[8:11], s46 offen lds
    s_waitcnt vmcnt(6)
    s_add_u32 m0, s43, 32768
    s_nop 0
    buffer_load_dwordx4 v8, s[12:15], s46 offen lds
    s_waitcnt vmcnt(6)
    s_add_u32 m0, s43, 33792
    s_nop 0
    buffer_load_dwordx4 v9, s[12:15], s46 offen lds
    s_waitcnt vmcnt(6)
    s_add_u32 m0, s44, 4096
    s_nop 0
    buffer_load_dwordx4 v10, s[8:11], s46 offen lds
    s_waitcnt vmcnt(6)
    s_add_u32 m0, s44, 16384
    s_nop 0
    buffer_load_dwordx4 v11, s[12:15], s46 offen lds
    s_waitcnt vmcnt(6)
    s_mov_b64 exec, 1
    ds_add_u32 v1, v2 offset:0
    s_mov_b64 exec, -1
k_sg_32:
    s_cmp_eq_u32 s51, 0
    s_cbranch_scc1 k_cg_24
    s_setprio 3
    ds_read_b64_tr_b16 v[24:25], v18 offset:0
    ds_read_b64_tr_b16 v[26:27], v18 offset:24576
    ds_read_b64_tr_b16 v[28:29], v19 offset:0
    ds_read_b64_tr_b16 v[30:31], v18 offset:512
    ds_read_b64_tr_b16 v[32:33], v18 offset:25088
    ds_read_b64_tr_b16 v[34:35], v19 offset:256
    ds_read_b64_tr_b16 v[36:37], v18 offset:1024
    ds_read_b64_tr_b16 v[38:39], v18 offset:25600
    ds_read_b64_tr_b16 v[40:41], v19 offset:512
    ds_read_b64_tr_b16 v[42:43], v18 offset:1536
    ds_read_b64_tr_b16 v[44:45], v18 offset:26112
    ds_read_b64_tr_b16 v[46:47], v19 offset:768
    s_setprio 2
k_cg_24:
    s_add_u32 m0, s42, 16384
    s_nop 0
    buffer_load_dwordx4 v4, s[4:7], s45 offen lds
    s_waitcnt vmcnt(6)
    s_add_u32 m0, s42, 17408
    s_nop 0
    buffer_load_dwordx4 v5, s[4:7], s45 offen lds
    s_waitcnt vmcnt(6)
    s_cmp_eq_u32 s51, 0
    s_cbranch_scc1 k_cg_25
    s_setprio 3
    s_waitcnt lgkmcnt(0)
    v_lshlrev_b32 v23, 16, v24
    v_and_b32 v24, 0xffff0000, v24
    v_add_f32 v20, v23, v24
    v_lshlrev_b32 v23, 16, v25
    v_and_b32 v25, 0xffff0000, v25
    v_add_f32 v20, v20, v23
    v_add_f32 v20, v20, v25
    v_lshlrev_b32 v23, 16, v26
    v_and_b32 v26, 0xffff0000, v26
    v_add_f32 v21, v23, v26
    v_lshlrev_b32 v23, 16, v27
    v_and_b32 v27, 0xffff0000, v27
    v_add_f32 v21, v21, v23
    v_add_f32 v21, v21, v27
    v_lshlrev_b32 v23, 16, v28
    v_and_b32 v28, 0xffff0000, v28
    v_add_f32 v22, v23, v28
    v_lshlrev_b32 v23, 16, v29
    v_and_b32 v29, 0xffff0000, v29
    v_add_f32 v22, v22, v23
    v_add_f32 v22, v22, v29
    s_setprio 2
k_cg_25:
    s_add_u32 m0, s42, 18432
    s_nop 0
    buffer_load_dwordx4 v6, s[4:7], s45 offen lds
    s_waitcnt vmcnt(6)
    s_cmp_eq_u32 s51, 0
    s_cbranch_scc1 k_cg_26
    s_setprio 3
    v_lshlrev_b32 v23, 16, v30
    v_and_b32 v30, 0xffff0000, v30
    v_add_f32 v20, v20, v23
    v_add_f32 v20, v20, v30
    v_lshlrev_b32 v23, 16, v31
    v_and_b32 v31, 0xffff0000, v31
    v_add_f32 v20, v20, v23
    v_add_f32 v20, v20, v31
    v_lshlrev_b32 v23, 16, v32
    v_and_b32 v32, 0xffff0000, v32
    v_add_f32 v21, v21, v23
    v_add_f32 v21, v21, v32
    v_lshlrev_b32 v23, 16, v33
    v_and_b32 v33, 0xffff0000, v33
    v_add_f32 v21, v21, v23
    v_add_f32 v21, v21, v33
    v_lshlrev_b32 v23, 16, v34
    v_and_b32 v34, 0xffff0000, v34
    v_add_f32 v22, v22, v23
    v_add_f32 v22, v22, v34
    v_lshlrev_b32 v23, 16, v35
    v_and_b32 v35, 0xffff0000, v35
    v_add_f32 v22, v22, v23
    v_add_f32 v22, v22, v35
    s_setprio 2
k_cg_26:
    s_add_u32 m0, s42, 19456
    s_nop 0
    buffer_load_dwordx4 v7, s[4:7], s45 offen lds
    s_waitcnt vmcnt(6)
    s_cmp_eq_u32 s51, 0
    s_cbranch_scc1 k_cg_27
    s_setprio 3
    v_lshlrev_b32 v23, 16, v36
    v_and_b32 v36, 0xffff0000, v36
    v_add_f32 v20, v20, v23
    v_add_f32 v20, v20, v36
    v_lshlrev_b32 v23, 16, v37
    v_and_b32 v37, 0xffff0000, v37
    v_add_f32 v20, v20, v23
    v_add_f32 v20, v20, v37
    v_lshlrev_b32 v23, 16, v38
    v_and_b32 v38, 0xffff0000, v38
    v_add_f32 v21, v21, v23
    v_add_f32 v21, v21, v38
    v_lshlrev_b32 v23, 16, v39
    v_and_b32 v39, 0xffff0000, v39
    v_add_f32 v21, v21, v23
    v_add_f32 v21, v21, v39
    v_lshlrev_b32 v23, 16, v40
    v_and_b32 v40, 0xffff0000, v40
    v_add_f32 v22, v22, v23
    v_add_f32 v22, v22, v40
    v_lshlrev_b32 v23, 16, v41
    v_and_b32 v41, 0xffff0000, v41
    v_add_f32 v22, v22, v23
    v_add_f32 v22, v22, v41
    s_setprio 2
k_cg_27:
    s_add_u32 s45, s45, 128
    s_add_u32 s46, s46, 196608
    s_cmp_eq_u32 s45, 1280
    s_cselect_b32 s45, 0, s45
    s_cselect_b32 s46, 0, s46
    s_add_u32 m0, s43, 16384
    s_nop 0
    buffer_load_dwordx4 v8, s[8:11], s46 offen lds
    s_waitcnt vmcnt(6)
    s_cmp_eq_u32 s51, 0
    s_cbranch_scc1 k_cg_28
    s_setprio 3
    v_lshlrev_b32 v23, 16, v42
    v_and_b32 v42, 0xffff0000, v42
    v_add_f32 v20, v20, v23
    v_add_f32 v20, v20, v42
    v_lshlrev_b32 v23, 16, v43
    v_and_b32 v43, 0xffff0000, v43
    v_add_f32 v20, v20, v23
    v_add_f32 v20, v20, v43
    v_lshlrev_b32 v23, 16, v44
    v_and_b32 v44, 0xffff0000, v44
    v_add_f32 v21, v21, v23
    v_add_f32 v21, v21, v44
    v_lshlrev_b32 v23, 16, v45
    v_and_b32 v45, 0xffff0000, v45
    v_add_f32 v21, v21, v23
    v_add_f32 v21, v21, v45
    v_lshlrev_b32 v23, 16, v46
    v_and_b32 v46, 0xffff0000, v46
    v_add_f32 v22, v22, v23
    v_add_f32 v22, v22, v46
    v_lshlrev_b32 v23, 16, v47
    v_and_b32 v47, 0xffff0000, v47
    v_add_f32 v22, v22, v23
    v_add_f32 v22, v22, v47
    ds_write2st64_b32 v13, v20, v21 offset0:0 offset1:1
    ds_write_b32 v13, v22 offset:512
    s_mov_b64 exec, 1
    ds_add_u32 v1, v2 offset:296
    s_mov_b64 exec, -1
    s_setprio 2
k_cg_28:
    s_add_u32 m0, s43, 17408
    s_nop 0
    buffer_load_dwordx4 v9, s[8:11], s46 offen lds
    s_waitcnt vmcnt(6)
    s_add_u32 m0, s43, 40960
    s_nop 0
    buffer_load_dwordx4 v8, s[12:15], s46 offen lds
    s_waitcnt vmcnt(6)
    s_add_u32 m0, s43, 41984
    s_nop 0
    buffer_load_dwordx4 v9, s[12:15], s46 offen lds
    s_waitcnt vmcnt(6)
    s_cmp_eq_u32 s51, 0
    s_cbranch_scc1 k_cg_30
    s_setprio 3
    s_cmp_eq_u32 s41, 3
    s_cbranch_scc1 k_csk
k_x_31:
    ds_read_b32 v3, v1 offset:296
    ds_read2st64_b32 v[20:21], v14 offset0:0 offset1:3
    ds_read2st64_b32 v[22:23], v14 offset0:6 offset1:9
    s_add_u32 s35, s35, 1
    s_waitcnt lgkmcnt(2)
    v_readfirstlane_b32 s37, v3
    s_cmp_eq_u32 s37, 4
    s_cbranch_scc1 k_x_31_x
    s_cmp_lt_u32 s35, 2097152
    s_cbranch_scc1 k_x_31
k_x_31_x:
    s_waitcnt lgkmcnt(0)
    v_add_f32 v20, v20, v21
    v_add_f32 v22, v22, v23
    v_add_f32 v20, v20, v22
    buffer_store_dword v20, v12, s[16:19], s47 offen sc1
k_csk:
    s_setprio 2
k_cg_30:
    s_add_u32 m0, s44, 8192
    s_nop 0
    buffer_load_dwordx4 v10, s[8:11], s46 offen lds
    s_waitcnt vmcnt(6)
    s_add_u32 m0, s44, 20480
    s_nop 0
    buffer_load_dwordx4 v11, s[12:15], s46 offen lds
    s_waitcnt vmcnt(6)
    s_mov_b64 exec, 1
    ds_add_u32 v1, v2 offset:4
    s_mov_b64 exec, -1
k_sg_33:
    s_add_u32 m0, s42, 32768
    s_nop 0
    buffer_load_dwordx4 v4, s[4:7], s45 offen lds
    s_waitcnt vmcnt(6)
    s_add_u32 m0, s42, 33792
    s_nop 0
    buffer_load_dwordx4 v5, s[4:7], s45 offen lds
    s_waitcnt vmcnt(6)
    ds_read_b32 v15, v1 offset:64
    s_add_u32 m0, s42, 34816
    s_nop 0
    buffer_load_dwordx4 v6, s[4:7], s45 offen lds
    s_waitcnt vmcnt(6)
    s_add_u32 m0, s42, 35840
    s_nop 0
    buffer_load_dwordx4 v7, s[4:7], s45 offen lds
    s_waitcnt vmcnt(6)
    s_add_u32 s45, s45, 128
    s_add_u32 s46, s46, 196608
    s_cmp_eq_u32 s45, 1280
    s_cselect_b32 s45, 0, s45
    s_cselect_b32 s46, 0, s46
    s_mov_b32 s52, 1
    s_waitcnt lgkmcnt(0)
    v_readfirstlane_b32 s37, v15
    s_cmp_eq_u32 s37, 4
    s_cbranch_scc1 k_fr_34
    s_mov_b32 s52, 0
    s_waitcnt vmcnt(0)
    s_mov_b64 exec, 1
    ds_add_u32 v1, v2 offset:8
    s_mov_b64 exec, -1
k_w_35:
    ds_read_b32 v3, v1 offset:64
    s_waitcnt lgkmcnt(0)
    v_readfirstlane_b32 s37, v3
    s_add_u32 s35, s35, 1
    s_cmp_eq_u32 s37, 4
    s_cbranch_scc1 k_w_35_x
    s_sleep 1
    s_cmp_lt_u32 s35, 2097152
    s_cbranch_scc1 k_w_35
k_w_35_x:
k_fr_34:
    s_add_u32 m0, s43, 0
    s_nop 0
    buffer_load_dwordx4 v8, s[8:11], s46 offen lds
    s_waitcnt vmcnt(6)
    s_mov_b64 exec, 1
    ds_add_u32 v1, v2 offset:332
    s_mov_b64 exec, -1
    s_add_u32 m0, s43, 1024
    s_nop 0
    buffer_load_dwordx4 v9, s[8:11], s46 offen lds
    s_waitcnt vmcnt(6)
    s_add_u32 m0, s43, 24576
    s_nop 0
    buffer_load_dwordx4 v8, s[12:15], s46 offen lds
    s_waitcnt vmcnt(6)
    s_add_u32 m0, s43, 25600
    s_nop 0
    buffer_load_dwordx4 v9, s[12:15], s46 offen lds
    s_waitcnt vmcnt(6)
    s_add_u32 m0, s44, 0
    s_nop 0
    buffer_load_dwordx4 v10, s[8:11], s46 offen lds
    s_waitcnt vmcnt(6)
    s_add_u32 m0, s44, 12288
    s_nop 0
    buffer_load_dwordx4 v11, s[12:15], s46 offen lds
    s_waitcnt vmcnt(6)
    s_cmp_eq_u32 s52, 0
    s_cbranch_scc1 k_sg_36
    s_mov_b64 exec, 1
    ds_add_u32 v1, v2 offset:8
    s_mov_b64 exec, -1
k_sg_36:
    s_add_u32 m0, s42, 0
    s_nop 0
    buffer_load_dwordx4 v4, s[4:7], s45 offen lds
    s_waitcnt vmcnt(6)
    s_add_u32 m0, s42, 1024
    s_nop 0
    buffer_load_dwordx4 v5, s[4:7], s45 offen lds
    s_waitcnt vmcnt(6)
    ds_read_b32 v15, v1 offset:68
    s_add_u32 m0, s42, 2048
    s_nop 0
    buffer_load_dwordx4 v6, s[4:7], s45 offen lds
    s_waitcnt vmcnt(6)
    s_add_u32 m0, s42, 3072
    s_nop 0
    buffer_load_dwordx4 v7, s[4:7], s45 offen lds
    s_waitcnt vmcnt(6)
    s_add_u32 s45, s45, 128
    s_add_u32 s46, s46, 196608
    s_cmp_eq_u32 s45, 1280
    s_cselect_b32 s45, 0, s45
    s_cselect_b32 s46, 0, s46
    s_mov_b32 s52, 1
    s_waitcnt lgkmcnt(0)
    v_readfirstlane_b32 s37, v15
    s_cmp_eq_u32 s37, 4
    s_cbranch_scc1 k_fr_37
    s_mov_b32 s52, 0
    s_waitcnt vmcnt(0)
    s_mov_b64 exec, 1
    ds_add_u32 v1, v2 offset:12
    s_mov_b64 exec, -1
k_w_38:
    ds_read_b32 v3, v1 offset:68
    s_waitcnt lgkmcnt(0)
    v_readfirstlane_b32 s37, v3
    s_add_u32 s35, s35, 1
    s_cmp_eq_u32 s37, 4
    s_cbranch_scc1 k_w_38_x
    s_sleep 1
    s_cmp_lt_u32 s35, 2097152
    s_cbranch_scc1 k_w_38
k_w_38_x:
k_fr_37:
    s_add_u32 m0, s43, 8192
    s_nop 0
    buffer_load_dwordx4 v8, s[8:11], s46 offen lds
    s_waitcnt vmcnt(6)
    s_add_u32 m0, s43, 9216
    s_nop 0
    buffer_load_dwordx4 v9, s[8:11], s46 offen lds
    s_waitcnt vmcnt(6)
    s_add_u32 m0, s43, 32768
    s_nop 0
    buffer_load_dwordx4 v8, s[12:15], s46 offen lds
    s_waitcnt vmcnt(6)
    s_add_u32 m0, s43, 33792
    s_nop 0
    buffer_load_dwordx4 v9, s[12:15], s46 offen lds
    s_waitcnt vmcnt(6)
    s_add_u32 m0, s44, 4096
    s_nop 0
    buffer_load_dwordx4 v10, s[8:11], s46 offen lds
    s_waitcnt vmcnt(6)
    s_add_u32 m0, s44, 16384
    s_nop 0
    buffer_load_dwordx4 v11, s[12:15], s46 offen lds
    s_waitcnt vmcnt(6)
    s_cmp_eq_u32 s52, 0
    s_cbranch_scc1 k_sg_39
    s_mov_b64 exec, 1
    ds_add_u32 v1, v2 offset:12
    s_mov_b64 exec, -1
k_sg_39:
    s_add_u32 m0, s42, 16384
    s_nop 0
    buffer_load_dwordx4 v4, s[4:7], s45 offen lds
    s_waitcnt vmcnt(6)
    s_add_u32 m0, s42, 17408
    s_nop 0
    buffer_load_dwordx4 v5, s[4:7], s45 offen lds
    s_waitcnt vmcnt(6)
    ds_read_b32 v15, v1 offset:72
    s_add_u32 m0, s42, 18432
    s_nop 0
    buffer_load_dwordx4 v6, s[4:7], s45 offen lds
    s_waitcnt vmcnt(6)
    s_add_u32 m0, s42, 19456
    s_nop 0
    buffer_load_dwordx4 v7, s[4:7], s45 offen lds
    s_waitcnt vmcnt(6)
    s_add_u32 s45, s45, 128
    s_add_u32 s46, s46, 196608
    s_cmp_eq_u32 s45, 1280
    s_cselect_b32 s45, 0, s45
    s_cselect_b32 s46, 0, s46
    s_mov_b32 s52, 1
    s_waitcnt lgkmcnt(0)
    v_readfirstlane_b32 s37, v15
    s_cmp_eq_u32 s37, 4
    s_cbranch_scc1 k_fr_40
    s_mov_b32 s52, 0
    s_waitcnt vmcnt(0)
    s_mov_b64 exec, 1
    ds_add_u32 v1, v2 offset:16
    s_mov_b64 exec, -1
k_w_41:
    ds_read_b32 v3, v1 offset:72
    s_waitcnt lgkmcnt(0)
    v_readfirstlane_b32 s37, v3
    s_add_u32 s35, s35, 1
    s_cmp_eq_u32 s37, 4
    s_cbranch_scc1 k_w_41_x
    s_sleep 1
    s_cmp_lt_u32 s35, 2097152
    s_cbranch_scc1 k_w_41
k_w_41_x:
k_fr_40:
    s_add_u32 m0, s43, 16384
    s_nop 0
    buffer_load_dwordx4 v8, s[8:11], s46 offen lds
    s_waitcnt vmcnt(6)
    s_add_u32 m0, s43, 17408
    s_nop 0
    buffer_load_dwordx4 v9, s[8:11], s46 offen lds
    s_waitcnt vmcnt(6)
    s_add_u32 m0, s43, 40960
    s_nop 0
    buffer_load_dwordx4 v8, s[12:15], s46 offen lds
    s_waitcnt vmcnt(6)
    s_add_u32 m0, s43, 41984
    s_nop 0
    buffer_load_dwordx4 v9, s[12:15], s46 offen lds
    s_waitcnt vmcnt(6)
    s_add_u32 m0, s44, 8192
    s_nop 0
    buffer_load_dwordx4 v10, s[8:11], s46 offen lds
    s_waitcnt vmcnt(6)
    s_add_u32 m0, s44, 20480
    s_nop 0
    buffer_load_dwordx4 v11, s[12:15], s46 offen lds
    s_waitcnt vmcnt(6)
    s_cmp_eq_u32 s52, 0
    s_cbranch_scc1 k_sg_42
    s_mov_b64 exec, 1
    ds_add_u32 v1, v2 offset:16
    s_mov_b64 exec, -1
k_sg_42:
    s_add_u32 m0, s42, 32768
    s_nop 0
    buffer_load_dwordx4 v4, s[4:7], s45 offen lds
    s_waitcnt vmcnt(6)
    s_add_u32 m0, s42, 33792
    s_nop 0
    buffer_load_dwordx4 v5, s[4:7], s45 offen lds
    s_waitcnt vmcnt(6)
    ds_read_b32 v15, v1 offset:76
    s_add_u32 m0, s42, 34816
    s_nop 0
    buffer_load_dwordx4 v6, s[4:7], s45 offen lds
    s_waitcnt vmcnt(6)
    s_add_u32 m0, s42, 35840
    s_nop 0
    buffer_load_dwordx4 v7, s[4:7], s45 offen lds
    s_waitcnt vmcnt(6)
    s_add_u32 s45, s45, 128
    s_add_u32 s46, s46, 196608
    s_cmp_eq_u32 s45, 1280
    s_cselect_b32 s45, 0, s45
    s_cselect_b32 s46, 0, s46
    s_mov_b32 s52, 1
    s_waitcnt lgkmcnt(0)
    v_readfirstlane_b32 s37, v15
    s_cmp_eq_u32 s37, 4
    s_cbranch_scc1 k_fr_43
    s_mov_b32 s52, 0
    s_waitcnt vmcnt(0)
    s_mov_b64 exec, 1
    ds_add_u32 v1, v2 offset:20
    s_mov_b64 exec, -1
k_w_44:
    ds_read_b32 v3, v1 offset:76
    s_waitcnt lgkmcnt(0)
    v_readfirstlane_b32 s37, v3
    s_add_u32 s35, s35, 1
    s_cmp_eq_u32 s37, 4
    s_cbranch_scc1 k_w_44_x
    s_sleep 1
    s_cmp_lt_u32 s35, 2097152
    s_cbranch_scc1 k_w_44
k_w_44_x:
k_fr_43:
    s_add_u32 m0, s43, 0
    s_nop 0
    buffer_load_dwordx4 v8, s[8:11], s46 offen lds
    s_waitcnt vmcnt(6)
    s_add_u32 m0, s43, 1024
    s_nop 0
    buffer_load_dwordx4 v9, s[8:11], s46 offen lds
    s_waitcnt vmcnt(6)
    s_add_u32 m0, s43, 24576
    s_nop 0
    buffer_load_dwordx4 v8, s[12:15], s46 offen lds
    s_waitcnt vmcnt(6)
    s_add_u32 m0, s43, 25600
    s_nop 0
    buffer_load_dwordx4 v9, s[12:15], s46 offen lds
    s_waitcnt vmcnt(6)
    s_add_u32 m0, s44, 0
    s_nop 0
    buffer_load_dwordx4 v10, s[8:11], s46 offen lds
    s_waitcnt vmcnt(6)
    s_add_u32 m0, s44, 12288
    s_nop 0
    buffer_load_dwordx4 v11, s[12:15], s46 offen lds
    s_waitcnt vmcnt(6)
    s_cmp_eq_u32 s52, 0
    s_cbranch_scc1 k_sg_45
    s_mov_b64 exec, 1
    ds_add_u32 v1, v2 offset:20
    s_mov_b64 exec, -1
k_sg_45:
    s_add_u32 m0, s42, 0
    s_nop 0
    buffer_load_dwordx4 v4, s[4:7], s45 offen lds
    s_waitcnt vmcnt(6)
    s_add_u32 m0, s42, 1024
    s_nop 0
    buffer_load_dwordx4 v5, s[4:7], s45 offen lds
    s_waitcnt vmcnt(6)
    ds_read_b32 v15, v1 offset:80
    s_add_u32 m0, s42, 2048
    s_nop 0
    buffer_load_dwordx4 v6, s[4:7], s45 offen lds
    s_waitcnt vmcnt(6)
    s_add_u32 m0, s42, 3072
    s_nop 0
    buffer_load_dwordx4 v7, s[4:7], s45 offen lds
    s_waitcnt vmcnt(6)
    s_add_u32 s45, s45, 128
    s_add_u32 s46, s46, 196608
    s_cmp_eq_u32 s45, 1280
    s_cselect_b32 s45, 0, s45
    s_cselect_b32 s46, 0, s46
    s_mov_b32 s52, 1
    s_waitcnt lgkmcnt(0)
    v_readfirstlane_b32 s37, v15
    s_cmp_eq_u32 s37, 4
    s_cbranch_scc1 k_fr_46
    s_mov_b32 s52, 0
    s_waitcnt vmcnt(0)
    s_mov_b64 exec, 1
    ds_add_u32 v1, v2 offset:24
    s_mov_b64 exec, -1
k_w_47:
    ds_read_b32 v3, v1 offset:80
    s_waitcnt lgkmcnt(0)
    v_readfirstlane_b32 s37, v3
    s_add_u32 s35, s35, 1
    s_cmp_eq_u32 s37, 4
    s_cbranch_scc1 k_w_47_x
    s_sleep 1
    s_cmp_lt_u32 s35, 2097152
    s_cbranch_scc1 k_w_47
k_w_47_x:
k_fr_46:
    s_add_u32 m0, s43, 8192
    s_nop 0
    buffer_load_dwordx4 v8, s[8:11], s46 offen lds
    s_waitcnt vmcnt(6)
    s_add_u32 m0, s43, 9216
    s_nop 0
    buffer_load_dwordx4 v9, s[8:11], s46 offen lds
    s_waitcnt vmcnt(6)
    s_add_u32 m0, s43, 32768
    s_nop 0
    buffer_load_dwordx4 v8, s[12:15], s46 offen lds
    s_waitcnt vmcnt(6)
    s_add_u32 m0, s43, 33792
    s_nop 0
    buffer_load_dwordx4 v9, s[12:15], s46 offen lds
    s_waitcnt vmcnt(6)
    s_add_u32 m0, s44, 4096
    s_nop 0
    buffer_load_dwordx4 v10, s[8:11], s46 offen lds
    s_waitcnt vmcnt(6)
    s_add_u32 m0, s44, 16384
    s_nop 0
    buffer_load_dwordx4 v11, s[12:15], s46 offen lds
    s_waitcnt vmcnt(6)
    s_cmp_eq_u32 s52, 0
    s_cbranch_scc1 k_sg_48
    s_mov_b64 exec, 1
    ds_add_u32 v1, v2 offset:24
    s_mov_b64 exec, -1
k_sg_48:
    s_add_u32 m0, s42, 16384
    s_nop 0
    buffer_load_dwordx4 v4, s[4:7], s45 offen lds
    s_waitcnt vmcnt(6)
    s_add_u32 m0, s42, 17408
    s_nop 0
    buffer_load_dwordx4 v5, s[4:7], s45 offen lds
    s_waitcnt vmcnt(6)
    ds_read_b32 v15, v1 offset:84
    s_add_u32 m0, s42, 18432
    s_nop 0
    buffer_load_dwordx4 v6, s[4:7], s45 offen lds
    s_waitcnt vmcnt(6)
    s_add_u32 m0, s42, 19456
    s_nop 0
    buffer_load_dwordx4 v7, s[4:7], s45 offen lds
    s_waitcnt vmcnt(6)
    s_add_u32 s45, s45, 128
    s_add_u32 s46, s46, 196608
    s_cmp_eq_u32 s45, 1280
    s_cselect_b32 s45, 0, s45
    s_cselect_b32 s46, 0, s46
    s_mov_b32 s52, 1
    s_waitcnt lgkmcnt(0)
    v_readfirstlane_b32 s37, v15
    s_cmp_eq_u32 s37, 4
    s_cbranch_scc1 k_fr_49
    s_mov_b32 s52, 0
    s_waitcnt vmcnt(0)
    s_mov_b64 exec, 1
    ds_add_u32 v1, v2 offset:28
    s_mov_b64 exec, -1
k_w_50:
    ds_read_b32 v3, v1 offset:84
    s_waitcnt lgkmcnt(0)
    v_readfirstlane_b32 s37, v3
    s_add_u32 s35, s35, 1
    s_cmp_eq_u32 s37, 4
    s_cbranch_scc1 k_w_50_x
    s_sleep 1
    s_cmp_lt_u32 s35, 2097152
    s_cbranch_scc1 k_w_50
k_w_50_x:
k_fr_49:
    s_add_u32 m0, s43, 16384
    s_nop 0
    buffer_load_dwordx4 v8, s[8:11], s46 offen lds
    s_waitcnt vmcnt(6)
    s_add_u32 m0, s43, 17408
    s_nop 0
    buffer_load_dwordx4 v9, s[8:11], s46 offen lds
    s_waitcnt vmcnt(6)
    s_add_u32 m0, s43, 40960
    s_nop 0
    buffer_load_dwordx4 v8, s[12:15], s46 offen lds
    s_waitcnt vmcnt(6)
    s_add_u32 m0, s43, 41984
    s_nop 0
    buffer_load_dwordx4 v9, s[12:15], s46 offen lds
    s_waitcnt vmcnt(6)
    s_add_u32 m0, s44, 8192
    s_nop 0
    buffer_load_dwordx4 v10, s[8:11], s46 offen lds
    s_waitcnt vmcnt(6)
    s_add_u32 m0, s44, 20480
    s_nop 0
    buffer_load_dwordx4 v11, s[12:15], s46 offen lds
    s_waitcnt vmcnt(6)
    s_cmp_eq_u32 s52, 0
    s_cbranch_scc1 k_sg_51
    s_mov_b64 exec, 1
    ds_add_u32 v1, v2 offset:28
    s_mov_b64 exec, -1
k_sg_51:
    s_add_u32 m0, s42, 32768
    s_nop 0
    buffer_load_dwordx4 v4, s[4:7], s45 offen lds
    s_waitcnt vmcnt(6)
    s_add_u32 m0, s42, 33792
    s_nop 0
    buffer_load_dwordx4 v5, s[4:7], s45 offen lds
    s_waitcnt vmcnt(6)
    ds_read_b32 v15, v1 offset:88
    s_add_u32 m0, s42, 34816
    s_nop 0
    buffer_load_dwordx4 v6, s[4:7], s45 offen lds
    s_waitcnt vmcnt(6)
    s_add_u32 m0, s42, 35840
    s_nop 0
    buffer_load_dwordx4 v7, s[4:7], s45 offen lds
    s_waitcnt vmcnt(6)
    s_cmp_lg_u32 s41, 3
    s_cbranch_scc1 k_l3a
k_w_29:
    ds_read_b32 v3, v1 offset:280
    s_waitcnt lgkmcnt(0)
    v_readfirstlane_b32 s37, v3
    s_add_u32 s35, s35, 1
    s_cmp_eq_u32 s37, 1
    s_cbranch_scc1 k_w_29_x
    s_cmp_lt_u32 s35, 2097152
    s_cbranch_scc1 k_w_29
k_w_29_x:
    s_mul_i32 s39, s36, 384
    s_add_u32 s39, s39, 22026240
    v_mov_b32 v17, s39
    s_mov_b64 exec, 1
    buffer_load_dword v16, v17, s[16:19], 0 offen sc1
    s_mov_b64 exec, -1
    s_cmp_ge_u32 s2, 128
    s_cbranch_scc1 k_l3a
    s_getpc_b64 s[56:57]
k_pcref2:
    s_sub_u32 s56, s56, k_pcref2-parallel_sum__spectral_gfnet__glu_gated_swiglu__prompt_kernel
    s_subb_u32 s57, s57, 0
    s_mov_b32 s58, k_tend-parallel_sum__spectral_gfnet__glu_gated_swiglu__prompt_kernel
    s_mov_b32 s59, 0x20000
    s_mul_i32 s37, s31, 2560
    v_lshlrev_b32 v19, 7, v0
    s_mov_b64 exec, 0xfffff
    buffer_load_dword v18, v19, s[56:59], s37 offen
    s_mov_b64 exec, -1
k_l3a:
    s_add_u32 s45, s45, 128
    s_add_u32 s46, s46, 196608
    s_cmp_eq_u32 s45, 1280
    s_cselect_b32 s45, 0, s45
    s_cselect_b32 s46, 0, s46
    s_mov_b32 s52, 1
    s_waitcnt lgkmcnt(0)
    v_readfirstlane_b32 s37, v15
    s_cmp_eq_u32 s37, 4
    s_cbranch_scc1 k_fr_52
    s_mov_b32 s52, 0
    s_waitcnt vmcnt(0)
    s_mov_b64 exec, 1
    ds_add_u32 v1, v2 offset:32
    s_mov_b64 exec, -1
k_w_53:
    ds_read_b32 v3, v1 offset:88
    s_waitcnt lgkmcnt(0)
    v_readfirstlane_b32 s37, v3
    s_add_u32 s35, s35, 1
    s_cmp_eq_u32 s37, 4
    s_cbranch_scc1 k_w_53_x
    s_sleep 1
    s_cmp_lt_u32 s35, 2097152
    s_cbranch_scc1 k_w_53
k_w_53_x:
k_fr_52:
    s_add_u32 m0, s43, 0
    s_nop 0
    buffer_load_dwordx4 v8, s[8:11], s46 offen lds
    s_waitcnt vmcnt(6)
    s_add_u32 m0, s43, 1024
    s_nop 0
    buffer_load_dwordx4 v9, s[8:11], s46 offen lds
    s_waitcnt vmcnt(6)
    s_add_u32 m0, s43, 24576
    s_nop 0
    buffer_load_dwordx4 v8, s[12:15], s46 offen lds
    s_waitcnt vmcnt(6)
    s_add_u32 m0, s43, 25600
    s_nop 0
    buffer_load_dwordx4 v9, s[12:15], s46 offen lds
    s_waitcnt vmcnt(6)
    s_add_u32 m0, s44, 0
    s_nop 0
    buffer_load_dwordx4 v10, s[8:11], s46 offen lds
    s_waitcnt vmcnt(6)
    s_add_u32 m0, s44, 12288
    s_nop 0
    buffer_load_dwordx4 v11, s[12:15], s46 offen lds
    s_waitcnt vmcnt(6)
    s_cmp_eq_u32 s52, 0
    s_cbranch_scc1 k_sg_54
    s_mov_b64 exec, 1
    ds_add_u32 v1, v2 offset:32
    s_mov_b64 exec, -1
k_sg_54:
    s_add_u32 m0, s42, 0
    s_nop 0
    buffer_load_dwordx4 v4, s[4:7], s45 offen lds
    s_waitcnt vmcnt(6)
    s_add_u32 m0, s42, 1024
    s_nop 0
    buffer_load_dwordx4 v5, s[4:7], s45 offen lds
    s_waitcnt vmcnt(6)
    ds_read_b32 v15, v1 offset:92
    s_add_u32 m0, s42, 2048
    s_nop 0
    buffer_load_dwordx4 v6, s[4:7], s45 offen lds
    s_waitcnt vmcnt(6)
    s_add_u32 m0, s42, 3072
    s_nop 0
    buffer_load_dwordx4 v7, s[4:7], s45 offen lds
    s_waitcnt vmcnt(6)
    s_add_u32 s45, s45, 128
    s_add_u32 s46, s46, 196608
    s_cmp_eq_u32 s45, 1280
    s_cselect_b32 s45, 0, s45
    s_cselect_b32 s46, 0, s46
    ds_read_b32 v3, v1 offset:336
    s_mov_b32 s52, 1
    s_waitcnt lgkmcnt(0)
    v_readfirstlane_b32 s37, v3
    s_cmp_eq_u32 s37, 1
    s_cbranch_scc1 k_lgo
    s_mov_b32 s52, 0
    s_waitcnt vmcnt(0)
    s_mov_b64 exec, 1
    ds_add_u32 v1, v2 offset:36
    s_mov_b64 exec, -1
k_w_55:
    ds_read_b32 v3, v1 offset:336
    s_waitcnt lgkmcnt(0)
    v_readfirstlane_b32 s37, v3
    s_add_u32 s35, s35, 1
    s_cmp_eq_u32 s37, 1
    s_cbranch_scc1 k_w_55_x
    s_sleep 1
    s_cmp_lt_u32 s35, 2097152
    s_cbranch_scc1 k_w_55
k_w_55_x:
k_lgo:
    s_cmp_lg_u32 s41, 3
    s_cbranch_scc1 k_lst
    s_lshl_b32 s37, s32, 10
    s_add_u32 s37, s37, 18087936
    v_lshlrev_b32 v13, 4, v0
    s_mov_b32 m0, 162816
    s_nop 0
    buffer_load_dwordx4 v13, s[16:19], s37 offen sc1 lds
    s_waitcnt vmcnt(1)
    s_branch k_lse
k_lst:
    s_mul_i32 s37, s33, 7680
    s_add_u32 s37, s37, 17825792
    s_lshl_b32 s38, s41, 8
    v_lshl_add_u32 v13, v0, 2, s38
    buffer_load_dword v24, v13, s[16:19], s37 offen offset:0 sc1
    buffer_load_dword v25, v13, s[16:19], s37 offen offset:768 sc1
    buffer_load_dword v26, v13, s[16:19], s37 offen offset:1536 sc1
    buffer_load_dword v27, v13, s[16:19], s37 offen offset:2304 sc1
    buffer_load_dword v28, v13, s[16:19], s37 offen offset:3072 sc1
    s_add_u32 s37, s37, 3840
    buffer_load_dword v29, v13, s[16:19], s37 offen offset:0 sc1
    buffer_load_dword v30, v13, s[16:19], s37 offen offset:768 sc1
    buffer_load_dword v31, v13, s[16:19], s37 offen offset:1536 sc1
    buffer_load_dword v32, v13, s[16:19], s37 offen offset:2304 sc1
    buffer_load_dword v33, v13, s[16:19], s37 offen offset:3072 sc1
    s_waitcnt vmcnt(10)
k_lse:
    s_cmp_eq_u32 s52, 0
    s_cbranch_scc1 k_l9
    s_mov_b64 exec, 1
    ds_add_u32 v1, v2 offset:36
    s_mov_b64 exec, -1
k_l9:
    s_cmp_lg_u32 s41, 3
    s_cbranch_scc1 k_l3b
    v_readfirstlane_b32 s37, v16
    s_cmp_eq_u32 s37, 32
    s_cbranch_scc1 k_l3c
    s_mov_b64 exec, 1
k_g_56:
    buffer_load_dword v16, v17, s[16:19], 0 offen sc1
    s_waitcnt vmcnt(0)
    v_cmp_ne_u32 vcc, 32, v16
    s_add_u32 s35, s35, 1
    s_cmp_eq_u64 vcc, 0
    s_cbranch_scc1 k_g_56_x
    s_sleep 4
    s_cmp_lt_u32 s35, 2097152
    s_cbranch_scc1 k_g_56
k_g_56_x:
    s_mov_b64 exec, -1
k_l3c:
    s_mov_b64 exec, 1
    ds_add_u32 v1, v2 offset:340
    s_mov_b64 exec, -1
k_l3b:
k_w_57:
    ds_read_b32 v3, v1 offset:340
    s_waitcnt lgkmcnt(0)
    v_readfirstlane_b32 s37, v3
    s_add_u32 s35, s35, 1
    s_cmp_eq_u32 s37, 1
    s_cbranch_scc1 k_w_57_x
    s_cmp_lt_u32 s35, 2097152
    s_cbranch_scc1 k_w_57
k_w_57_x:
    v_lshlrev_b32 v12, 4, v0
    s_mul_i32 s37, s36, 48
    s_mul_i32 s38, s41, 12
    s_add_u32 s37, s37, s38
    s_mul_i32 s48, s37, 5120
    s_add_u32 s48, s48, 12582912
    s_lshl_b32 s38, s41, 2
    v_add_u32 v14, s38, v1
    v_add_u32 v4, s42, v12
    v_add_u32 v5, s43, v12
    v_add_u32 v6, s44, v12
k_w_58:
    ds_read_b32 v3, v1 offset:92
    s_waitcnt lgkmcnt(0)
    v_readfirstlane_b32 s37, v3
    s_add_u32 s35, s35, 1
    s_cmp_eq_u32 s37, 4
    s_cbranch_scc1 k_w_58_x
    s_sleep 1
    s_cmp_lt_u32 s35, 2097152
    s_cbranch_scc1 k_w_58
k_w_58_x:
    s_add_u32 m0, s43, 8192
    s_add_u32 s46, s48, 46080
    buffer_load_dwordx4 v12, s[16:19], s46 offen sc1 lds
    s_waitcnt vmcnt(6)
    s_waitcnt vmcnt(1)
    s_cmp_eq_u32 s41, 3
    s_cbranch_scc1 k_lfin
    v_add_f32 v24, v24, v29
    v_add_f32 v25, v25, v30
    v_add_f32 v26, v26, v31
    v_add_f32 v27, v27, v32
    v_add_f32 v28, v28, v33
    v_add_f32 v24, v24, v25
    v_add_f32 v26, v26, v27
    v_add_f32 v24, v24, v28
    v_add_f32 v24, v24, v26
    v_lshlrev_b32 v13, 1, v13
    v_add_u32 v13, 161280, v13
    v_and_b32 v28, 0xffff0000, v24
    v_sub_f32 v24, v24, v28
    v_and_b32 v29, 0xffff0000, v24
    v_sub_f32 v24, v24, v29
    v_lshrrev_b32 v28, 16, v28
    v_or_b32 v26, v28, v29
    v_lshrrev_b32 v27, 16, v24
    ds_write_b64 v13, v[26:27]
    s_waitcnt lgkmcnt(0)
k_lfin:
    s_mov_b64 exec, 1
    ds_add_u32 v1, v2 offset:272
    s_mov_b64 exec, -1
    s_lshr_b32 s37, s31, 2
    s_lshl_b32 s37, s37, 2
    s_add_u32 s37, s37, s41
    s_mul_i32 s37, s37, 7680
    s_mul_i32 s38, s36, 245760
    s_add_u32 s37, s37, s38
    s_add_u32 s37, s37, 12582912
    v_lshlrev_b32 v16, 7, v0
    s_mov_b32 exec_hi, 0x0fffffff
    buffer_load_dword v17, v16, s[16:19], s37 offen sc1
    s_mov_b32 exec_hi, -1
    s_add_u32 m0, s43, 9216
    s_add_u32 s46, s48, 47104
    buffer_load_dwordx4 v12, s[16:19], s46 offen sc1 lds
    s_waitcnt vmcnt(6)
    s_add_u32 m0, s43, 32768
    s_add_u32 s46, s48, 48128
    buffer_load_dwordx4 v12, s[16:19], s46 offen sc1 lds
    s_waitcnt vmcnt(6)
    s_add_u32 m0, s43, 33792
    s_add_u32 s46, s48, 49152
    buffer_load_dwordx4 v12, s[16:19], s46 offen sc1 lds
    s_waitcnt vmcnt(6)
    s_add_u32 m0, s44, 4096
    s_add_u32 s46, s48, 50176
    buffer_load_dwordx4 v12, s[16:19], s46 offen sc1 lds
    s_waitcnt vmcnt(6)
    s_add_u32 m0, s44, 16384
    s_add_u32 s46, s48, 51200
    buffer_load_dwordx4 v12, s[16:19], s46 offen sc1 lds
    s_waitcnt vmcnt(6)
    s_add_u32 m0, s42, 16384
    s_add_u32 s46, s48, 52224
    buffer_load_dwordx4 v12, s[16:19], s46 offen sc1 lds
    s_waitcnt vmcnt(6)
    s_add_u32 m0, s42, 17408
    s_add_u32 s46, s48, 53248
    buffer_load_dwordx4 v12, s[16:19], s46 offen sc1 lds
    s_waitcnt vmcnt(6)
    s_add_u32 m0, s42, 18432
    s_add_u32 s46, s48, 54272
    buffer_load_dwordx4 v12, s[16:19], s46 offen sc1 lds
    s_waitcnt vmcnt(6)
    s_add_u32 m0, s42, 19456
    s_add_u32 s46, s48, 55296
    buffer_load_dwordx4 v12, s[16:19], s46 offen sc1 lds
    s_waitcnt vmcnt(6)
    s_add_u32 s46, s48, 15360
    buffer_load_dwordx4 v[40:43], v12, s[16:19], s46 offen sc1
    s_waitcnt vmcnt(6)
    s_add_u32 s46, s48, 16384
    buffer_load_dwordx4 v[44:47], v12, s[16:19], s46 offen sc1
    s_waitcnt vmcnt(6)
    s_add_u32 s46, s48, 17408
    buffer_load_dwordx4 v[48:51], v12, s[16:19], s46 offen sc1
    s_waitcnt vmcnt(6)
    s_add_u32 s46, s48, 18432
    buffer_load_dwordx4 v[52:55], v12, s[16:19], s46 offen sc1
    s_waitcnt vmcnt(6)
    s_add_u32 s46, s48, 19456
    buffer_load_dwordx4 v[56:59], v12, s[16:19], s46 offen sc1
    s_waitcnt vmcnt(6)
    s_add_u32 s46, s48, 20480
    buffer_load_dwordx4 v[60:63], v12, s[16:19], s46 offen sc1
    s_waitcnt vmcnt(6)
    s_mov_b64 exec, 1
    ds_add_u32 v14, v2 offset:128
    s_mov_b64 exec, -1
    s_add_u32 s46, s48, 21504
    buffer_load_dwordx4 v[64:67], v12, s[16:19], s46 offen sc1
    s_waitcnt vmcnt(6)
    s_add_u32 s46, s48, 22528
    buffer_load_dwordx4 v[68:71], v12, s[16:19], s46 offen sc1
    s_waitcnt vmcnt(6)
    s_add_u32 s46, s48, 23552
    buffer_load_dwordx4 v[72:75], v12, s[16:19], s46 offen sc1
    s_waitcnt vmcnt(6)
    s_add_u32 s46, s48, 24576
    buffer_load_dwordx4 v[76:79], v12, s[16:19], s46 offen sc1
    s_waitcnt vmcnt(6)
k_w_59:
    ds_read_b32 v3, v1 offset:96
    s_waitcnt lgkmcnt(0)
    v_readfirstlane_b32 s37, v3
    s_add_u32 s35, s35, 1
    s_cmp_eq_u32 s37, 4
    s_cbranch_scc1 k_w_59_x
    s_sleep 1
    s_cmp_lt_u32 s35, 2097152
    s_cbranch_scc1 k_w_59
k_w_59_x:
    s_add_u32 m0, s43, 16384
    s_add_u32 s46, s48, 56320
    buffer_load_dwordx4 v12, s[16:19], s46 offen sc1 lds
    s_waitcnt vmcnt(6)
    s_add_u32 m0, s43, 17408
    s_add_u32 s46, s48, 57344
    buffer_load_dwordx4 v12, s[16:19], s46 offen sc1 lds
    s_waitcnt vmcnt(6)
    s_add_u32 m0, s43, 40960
    s_add_u32 s46, s48, 58368
    buffer_load_dwordx4 v12, s[16:19], s46 offen sc1 lds
    s_waitcnt vmcnt(6)
    s_add_u32 m0, s43, 41984
    s_add_u32 s46, s48, 59392
    buffer_load_dwordx4 v12, s[16:19], s46 offen sc1 lds
    s_waitcnt vmcnt(6)
    s_add_u32 m0, s44, 8192
    s_add_u32 s46, s48, 60416
    buffer_load_dwordx4 v12, s[16:19], s46 offen sc1 lds
    s_waitcnt vmcnt(6)
    s_add_u32 m0, s44, 20480
    s_add_u32 s46, s48, 30720
    buffer_load_dwordx4 v12, s[16:19], s46 offen sc1 lds
    s_waitcnt vmcnt(6)
    s_add_u32 m0, s42, 32768
    s_add_u32 s46, s48, 31744
    buffer_load_dwordx4 v12, s[16:19], s46 offen sc1 lds
    s_waitcnt vmcnt(6)
    s_add_u32 m0, s42, 33792
    s_add_u32 s46, s48, 32768
    buffer_load_dwordx4 v12, s[16:19], s46 offen sc1 lds
    s_waitcnt vmcnt(6)
    s_add_u32 m0, s42, 34816
    s_add_u32 s46, s48, 33792
    buffer_load_dwordx4 v12, s[16:19], s46 offen sc1 lds
    s_waitcnt vmcnt(6)
    s_add_u32 m0, s42, 35840
    s_add_u32 s46, s48, 34816
    buffer_load_dwordx4 v12, s[16:19], s46 offen sc1 lds
    s_waitcnt vmcnt(6)
    s_add_u32 s46, s48, 25600
    buffer_load_dwordx4 v[80:83], v12, s[16:19], s46 offen sc1
    s_waitcnt vmcnt(6)
    s_add_u32 s46, s48, 26624
    buffer_load_dwordx4 v[84:87], v12, s[16:19], s46 offen sc1
    s_waitcnt vmcnt(6)
    s_add_u32 s46, s48, 27648
    buffer_load_dwordx4 v[88:91], v12, s[16:19], s46 offen sc1
    s_waitcnt vmcnt(6)
    s_add_u32 s46, s48, 28672
    buffer_load_dwordx4 v[92:95], v12, s[16:19], s46 offen sc1
    s_waitcnt vmcnt(6)
    s_add_u32 s46, s48, 29696
    buffer_load_dwordx4 v[96:99], v12, s[16:19], s46 offen sc1
    s_waitcnt vmcnt(6)
    s_add_u32 s46, s48, 0
    buffer_load_dwordx4 v[100:103], v12, s[16:19], s46 offen sc1
    s_waitcnt vmcnt(6)
    s_mov_b64 exec, 1
    ds_add_u32 v14, v2 offset:144
    s_mov_b64 exec, -1
    s_add_u32 s46, s48, 1024
    buffer_load_dwordx4 v[104:107], v12, s[16:19], s46 offen sc1
    s_waitcnt vmcnt(6)
    s_add_u32 s46, s48, 2048
    buffer_load_dwordx4 v[108:111], v12, s[16:19], s46 offen sc1
    s_waitcnt vmcnt(6)
    s_add_u32 s46, s48, 3072
    buffer_load_dwordx4 v[112:115], v12, s[16:19], s46 offen sc1
    s_waitcnt vmcnt(6)
    s_add_u32 s46, s48, 4096
    buffer_load_dwordx4 v[116:119], v12, s[16:19], s46 offen sc1
    s_waitcnt vmcnt(6)
k_w_60:
    ds_read_b32 v3, v1 offset:100
    s_waitcnt lgkmcnt(0)
    v_readfirstlane_b32 s37, v3
    s_add_u32 s35, s35, 1
    s_cmp_eq_u32 s37, 4
    s_cbranch_scc1 k_w_60_x
    s_sleep 1
    s_cmp_lt_u32 s35, 2097152
    s_cbranch_scc1 k_w_60
k_w_60_x:
    s_add_u32 m0, s43, 0
    s_add_u32 s46, s48, 35840
    buffer_load_dwordx4 v12, s[16:19], s46 offen sc1 lds
    s_waitcnt vmcnt(6)
    s_add_u32 m0, s43, 1024
    s_add_u32 s46, s48, 36864
    buffer_load_dwordx4 v12, s[16:19], s46 offen sc1 lds
    s_waitcnt vmcnt(6)
    s_add_u32 m0, s43, 24576
    s_add_u32 s46, s48, 37888
    buffer_load_dwordx4 v12, s[16:19], s46 offen sc1 lds
    s_waitcnt vmcnt(6)
    s_add_u32 m0, s43, 25600
    s_add_u32 s46, s48, 38912
    buffer_load_dwordx4 v12, s[16:19], s46 offen sc1 lds
    s_waitcnt vmcnt(6)
    s_add_u32 m0, s44, 0
    s_add_u32 s46, s48, 39936
    buffer_load_dwordx4 v12, s[16:19], s46 offen sc1 lds
    s_waitcnt vmcnt(6)
    s_add_u32 m0, s44, 12288
    s_add_u32 s46, s48, 40960
    buffer_load_dwordx4 v12, s[16:19], s46 offen sc1 lds
    s_waitcnt vmcnt(6)
    s_add_u32 m0, s42, 0
    s_add_u32 s46, s48, 41984
    buffer_load_dwordx4 v12, s[16:19], s46 offen sc1 lds
    s_waitcnt vmcnt(6)
    s_add_u32 m0, s42, 1024
    s_add_u32 s46, s48, 43008
    buffer_load_dwordx4 v12, s[16:19], s46 offen sc1 lds
    s_waitcnt vmcnt(6)
    s_add_u32 m0, s42, 2048
    s_add_u32 s46, s48, 44032
    buffer_load_dwordx4 v12, s[16:19], s46 offen sc1 lds
    s_waitcnt vmcnt(6)
    s_add_u32 m0, s42, 3072
    s_add_u32 s46, s48, 45056
    buffer_load_dwordx4 v12, s[16:19], s46 offen sc1 lds
    s_waitcnt vmcnt(6)
    s_add_u32 s46, s48, 5120
    buffer_load_dwordx4 v[120:123], v12, s[16:19], s46 offen sc1
    s_waitcnt vmcnt(6)
    s_add_u32 s46, s48, 6144
    buffer_load_dwordx4 v[124:127], v12, s[16:19], s46 offen sc1
    s_waitcnt vmcnt(6)
    s_add_u32 s46, s48, 7168
    buffer_load_dwordx4 v[128:131], v12, s[16:19], s46 offen sc1
    s_waitcnt vmcnt(6)
    s_add_u32 s46, s48, 8192
    buffer_load_dwordx4 v[132:135], v12, s[16:19], s46 offen sc1
    s_waitcnt vmcnt(6)
    s_add_u32 s46, s48, 9216
    buffer_load_dwordx4 v[136:139], v12, s[16:19], s46 offen sc1
    s_waitcnt vmcnt(6)
    s_add_u32 s46, s48, 10240
    buffer_load_dwordx4 v[140:143], v12, s[16:19], s46 offen sc1
    s_waitcnt vmcnt(6)
    s_mov_b64 exec, 1
    ds_add_u32 v14, v2 offset:160
    s_mov_b64 exec, -1
    s_add_u32 s46, s48, 11264
    buffer_load_dwordx4 v[144:147], v12, s[16:19], s46 offen sc1
    s_waitcnt vmcnt(6)
    s_add_u32 s46, s48, 12288
    buffer_load_dwordx4 v[148:151], v12, s[16:19], s46 offen sc1
    s_waitcnt vmcnt(6)
    s_add_u32 s46, s48, 13312
    buffer_load_dwordx4 v[152:155], v12, s[16:19], s46 offen sc1
    s_waitcnt vmcnt(6)
    s_add_u32 s46, s48, 14336
    buffer_load_dwordx4 v[156:159], v12, s[16:19], s46 offen sc1
    s_waitcnt vmcnt(6)
    s_setprio 2
k_w_61:
    ds_read_b32 v3, v14 offset:224
    s_waitcnt lgkmcnt(0)
    v_readfirstlane_b32 s37, v3
    s_add_u32 s35, s35, 1
    s_cmp_ge_u32 s37, 1
    s_cbranch_scc1 k_w_61_x
    s_sleep 1
    s_cmp_lt_u32 s35, 2097152
    s_cbranch_scc1 k_w_61
k_w_61_x:
    ds_write_b128 v5, v[40:43] offset:8192
    ds_write_b128 v5, v[44:47] offset:9216
    ds_write_b128 v5, v[48:51] offset:32768
    ds_write_b128 v5, v[52:55] offset:33792
    ds_write_b128 v6, v[56:59] offset:4096
    s_mov_b64 exec, 1
    ds_add_u32 v14, v2 offset:176
    s_mov_b64 exec, -1
k_w_62:
    ds_read_b32 v3, v14 offset:224
    s_waitcnt lgkmcnt(0)
    v_readfirstlane_b32 s37, v3
    s_add_u32 s35, s35, 1
    s_cmp_ge_u32 s37, 2
    s_cbranch_scc1 k_w_62_x
    s_sleep 1
    s_cmp_lt_u32 s35, 2097152
    s_cbranch_scc1 k_w_62
k_w_62_x:
    ds_write_b128 v6, v[60:63] offset:16384
    ds_write_b128 v4, v[64:67] offset:16384
    ds_write_b128 v4, v[68:71] offset:17408
    ds_write_b128 v4, v[72:75] offset:18432
    ds_write_b128 v4, v[76:79] offset:19456
    s_mov_b64 exec, 1
    ds_add_u32 v14, v2 offset:176
    s_mov_b64 exec, -1
k_w_63:
    ds_read_b32 v3, v14 offset:224
    s_waitcnt lgkmcnt(0)
    v_readfirstlane_b32 s37, v3
    s_add_u32 s35, s35, 1
    s_cmp_ge_u32 s37, 3
    s_cbranch_scc1 k_w_63_x
    s_sleep 1
    s_cmp_lt_u32 s35, 2097152
    s_cbranch_scc1 k_w_63
k_w_63_x:
    ds_write_b128 v5, v[80:83] offset:16384
    ds_write_b128 v5, v[84:87] offset:17408
    ds_write_b128 v5, v[88:91] offset:40960
    ds_write_b128 v5, v[92:95] offset:41984
    ds_write_b128 v6, v[96:99] offset:8192
    s_mov_b64 exec, 1
    ds_add_u32 v14, v2 offset:176
    s_mov_b64 exec, -1
k_w_64:
    ds_read_b32 v3, v14 offset:224
    s_waitcnt lgkmcnt(0)
    v_readfirstlane_b32 s37, v3
    s_add_u32 s35, s35, 1
    s_cmp_ge_u32 s37, 4
    s_cbranch_scc1 k_w_64_x
    s_sleep 1
    s_cmp_lt_u32 s35, 2097152
    s_cbranch_scc1 k_w_64
k_w_64_x:
    ds_write_b128 v6, v[100:103] offset:20480
    ds_write_b128 v4, v[104:107] offset:32768
    ds_write_b128 v4, v[108:111] offset:33792
    ds_write_b128 v4, v[112:115] offset:34816
    ds_write_b128 v4, v[116:119] offset:35840
    s_mov_b64 exec, 1
    ds_add_u32 v14, v2 offset:176
    s_mov_b64 exec, -1
    s_waitcnt vmcnt(0)
k_w_65:
    ds_read_b32 v3, v14 offset:224
    s_waitcnt lgkmcnt(0)
    v_readfirstlane_b32 s37, v3
    s_add_u32 s35, s35, 1
    s_cmp_ge_u32 s37, 5
    s_cbranch_scc1 k_w_65_x
    s_sleep 1
    s_cmp_lt_u32 s35, 2097152
    s_cbranch_scc1 k_w_65
k_w_65_x:
    ds_write_b128 v5, v[120:123] offset:0
    ds_write_b128 v5, v[124:127] offset:1024
    ds_write_b128 v5, v[128:131] offset:24576
    ds_write_b128 v5, v[132:135] offset:25600
    ds_write_b128 v6, v[136:139] offset:0
    s_mov_b64 exec, 1
    ds_add_u32 v14, v2 offset:176
    s_mov_b64 exec, -1
k_w_66:
    ds_read_b32 v3, v14 offset:224
    s_waitcnt lgkmcnt(0)
    v_readfirstlane_b32 s37, v3
    s_add_u32 s35, s35, 1
    s_cmp_ge_u32 s37, 6
    s_cbranch_scc1 k_w_66_x
    s_sleep 1
    s_cmp_lt_u32 s35, 2097152
    s_cbranch_scc1 k_w_66
k_w_66_x:
    ds_write_b128 v6, v[140:143] offset:12288
    ds_write_b128 v4, v[144:147] offset:0
    ds_write_b128 v4, v[148:151] offset:1024
    ds_write_b128 v4, v[152:155] offset:2048
    ds_write_b128 v4, v[156:159] offset:3072
    s_mov_b64 exec, 1
    ds_add_u32 v14, v2 offset:176
    s_mov_b64 exec, -1
    s_waitcnt lgkmcnt(0)
    s_branch k_fin
k_G:
    s_and_b32 s41, s3, 1
    s_lshr_b32 s42, s3, 1
    v_and_b32 v62, 31, v0
    v_lshrrev_b32 v63, 5, v0
    v_bfe_u32 v64, v62, 1, 3
    v_xor_b32 v64, v64, v63
    s_lshl_b32 s37, s41, 13
    v_lshlrev_b32 v62, 7, v62
    v_add_u32 v62, s37, v62
    v_xor_b32 v65, 0, v64
    v_lshl_add_u32 v4, v65, 4, v62
    v_xor_b32 v65, 2, v64
    v_lshl_add_u32 v5, v65, 4, v62
    v_xor_b32 v65, 4, v64
    v_lshl_add_u32 v6, v65, 4, v62
    v_xor_b32 v65, 6, v64
    v_lshl_add_u32 v7, v65, 4, v62
    v_bfe_u32 v62, v0, 2, 2
    v_lshl_add_u32 v62, v63, 3, v62
    v_and_b32 v64, 3, v0
    v_lshlrev_b32 v64, 3, v64
    v_bfe_u32 v65, v0, 4, 1
    v_bfe_u32 v66, v0, 3, 1
    v_xor_b32 v66, s42, v66
    v_lshlrev_b32 v66, 6, v66
    v_lshl_add_u32 v66, v62, 7, v66
    v_lshl_add_u32 v66, v65, 5, v66
    v_add_u32 v66, v66, v64
    v_add_u32 v8, 49152, v66
    v_xor_b32 v66, s42, v65
    v_lshlrev_b32 v66, 5, v66
    v_lshl_add_u32 v66, v62, 6, v66
    v_add_u32 v66, v66, v64
    v_mul_u32_u24 v65, 12288, v65
    v_add_u32 v66, v66, v65
    v_add_u32 v9, 98304, v66
    v_mov_b32 v10, 122880
    v_mov_b32 v72, 0
    v_mov_b32 v73, 0
    v_mov_b32 v74, 0
    v_mov_b32 v75, 0
    v_mov_b32 v76, 0
    v_mov_b32 v77, 0
    v_mov_b32 v78, 0
    v_mov_b32 v79, 0
    v_mov_b32 v80, 0
    v_mov_b32 v81, 0
    v_mov_b32 v82, 0
    v_mov_b32 v83, 0
    v_mov_b32 v84, 0
    v_mov_b32 v85, 0
    v_mov_b32 v86, 0
    v_mov_b32 v87, 0
    v_mov_b32 v88, 0
    v_mov_b32 v89, 0
    v_mov_b32 v90, 0
    v_mov_b32 v91, 0
    v_mov_b32 v92, 0
    v_mov_b32 v93, 0
    v_mov_b32 v94, 0
    v_mov_b32 v95, 0
    v_mov_b32 v96, 0
    v_mov_b32 v97, 0
    v_mov_b32 v98, 0
    v_mov_b32 v99, 0
    v_mov_b32 v100, 0
    v_mov_b32 v101, 0
    v_mov_b32 v102, 0
    v_mov_b32 v103, 0
    v_mov_b32 v104, 0
    v_mov_b32 v105, 0
    v_mov_b32 v106, 0
    v_mov_b32 v107, 0
    v_mov_b32 v108, 0
    v_mov_b32 v109, 0
    v_mov_b32 v110, 0
    v_mov_b32 v111, 0
    v_mov_b32 v112, 0
    v_mov_b32 v113, 0
    v_mov_b32 v114, 0
    v_mov_b32 v115, 0
    v_mov_b32 v116, 0
    v_mov_b32 v117, 0
    v_mov_b32 v118, 0
    v_mov_b32 v119, 0
    v_mov_b32 v120, 0
    v_mov_b32 v121, 0
    v_mov_b32 v122, 0
    v_mov_b32 v123, 0
    v_mov_b32 v124, 0
    v_mov_b32 v125, 0
    v_mov_b32 v126, 0
    v_mov_b32 v127, 0
    v_mov_b32 v128, 0
    v_mov_b32 v129, 0
    v_mov_b32 v130, 0
    v_mov_b32 v131, 0
    v_mov_b32 v132, 0
    v_mov_b32 v133, 0
    v_mov_b32 v134, 0
    v_mov_b32 v135, 0
    v_mov_b32 v136, 0
    v_mov_b32 v137, 0
    v_mov_b32 v138, 0
    v_mov_b32 v139, 0
    v_mov_b32 v140, 0
    v_mov_b32 v141, 0
    v_mov_b32 v142, 0
    v_mov_b32 v143, 0
    v_mov_b32 v144, 0
    v_mov_b32 v145, 0
    v_mov_b32 v146, 0
    v_mov_b32 v147, 0
    v_mov_b32 v148, 0
    v_mov_b32 v149, 0
    v_mov_b32 v150, 0
    v_mov_b32 v151, 0
    v_mov_b32 v152, 0
    v_mov_b32 v153, 0
    v_mov_b32 v154, 0
    v_mov_b32 v155, 0
    v_mov_b32 v156, 0
    v_mov_b32 v157, 0
    v_mov_b32 v158, 0
    v_mov_b32 v159, 0
    v_mov_b32 v160, 0
    v_mov_b32 v161, 0
    v_mov_b32 v162, 0
    v_mov_b32 v163, 0
    v_mov_b32 v164, 0
    v_mov_b32 v165, 0
    v_mov_b32 v166, 0
    v_mov_b32 v167, 0
    s_waitcnt lgkmcnt(0)
    s_mov_b32 s16, s82
    s_mov_b32 s17, s83
    s_mov_b32 s18, 268435456
    s_mov_b32 s19, 0x20000
    s_mov_b32 s20, s78
    s_mov_b32 s21, s79
    s_mov_b32 s22, 2621440
    s_mov_b32 s23, 0x20000
    s_lshl_b32 s40, s32, 1
    s_add_u32 s40, s40, s41
    s_lshl_b32 s40, s40, 2
    s_lshr_b32 s43, s33, 2
    s_add_u32 s40, s40, s43
    s_mul_i32 s59, s40, 384
    s_and_b32 s43, s33, 3
    s_lshl2_add_u32 s59, s43, s59
    s_add_u32 s59, s59, 22069248
    s_lshl_b32 s37, s28, 1
    s_add_u32 s37, s37, s29
    s_lshl_b32 s38, s37, 2
    s_add_u32 s38, s38, s3
    s_mul_i32 s38, s38, 384
    s_add_u32 s55, s38, 22069248
    s_mul_i32 s37, s37, 196608
    s_mul_i32 s38, s3, 12288
    s_add_u32 s37, s37, s38
    s_add_u32 s52, s37, 6291456
    s_add_u32 s38, s3, 0
    s_and_b32 s38, s38, 3
    s_mul_i32 s38, s38, 49152
    s_add_u32 s64, s38, s52
    s_add_u32 s38, s3, 1
    s_and_b32 s38, s38, 3
    s_mul_i32 s38, s38, 49152
    s_add_u32 s65, s38, s52
    s_add_u32 s38, s3, 2
    s_and_b32 s38, s38, 3
    s_mul_i32 s38, s38, 49152
    s_add_u32 s66, s38, s52
    s_add_u32 s38, s3, 3
    s_and_b32 s38, s38, 3
    s_mul_i32 s38, s38, 49152
    s_add_u32 s67, s38, s52
    s_lshl_b32 s37, s29, 2
    s_add_u32 s37, s37, s3
    s_lshl_b32 s37, s37, 8
    s_lshl_b32 s38, s28, 4
    s_add_u32 s37, s37, s38
    s_mul_i32 s37, s37, 1280
    s_mul_i32 s38, s36, 160
    s_add_u32 s56, s37, s38
    s_add_u32 s57, s56, 14680064
k_w_67:
    ds_read_b32 v3, v1 offset:0
    s_waitcnt lgkmcnt(0)
    v_readfirstlane_b32 s37, v3
    s_add_u32 s35, s35, 1
    s_cmp_eq_u32 s37, 4
    s_cbranch_scc1 k_w_67_x
    s_cmp_lt_u32 s35, 2097152
    s_cbranch_scc1 k_w_67
k_w_67_x:
    s_waitcnt vmcnt(0)
    s_setprio 1
    s_mov_b32 s47, 0
    ds_read_b128 v[12:15], v4 offset:0
    ds_read_b128 v[16:19], v4 offset:4096
    ds_read_b64_tr_b16 v[20:21], v8 offset:0
    ds_read_b64_tr_b16 v[22:23], v8 offset:512
    ds_read_b64_tr_b16 v[24:25], v8 offset:24576
    ds_read_b64_tr_b16 v[26:27], v8 offset:25088
    ds_read_b64_tr_b16 v[28:29], v9 offset:0
    ds_read_b64_tr_b16 v[30:31], v9 offset:256
    ds_read_b128 v[32:35], v5 offset:0
    ds_read_b128 v[36:39], v5 offset:4096
    ds_read_b64_tr_b16 v[40:41], v8 offset:2048
    ds_read_b64_tr_b16 v[42:43], v8 offset:2560
    ds_read_b64_tr_b16 v[44:45], v8 offset:26624
    ds_read_b64_tr_b16 v[46:47], v8 offset:27136
    ds_read_b64_tr_b16 v[48:49], v9 offset:1024
    ds_read_b64_tr_b16 v[50:51], v9 offset:1280
    s_branch k_gb0
k_gloop:
    s_waitcnt lgkmcnt(8)
    v_mfma_f32_32x32x16_bf16 v[72:87], v[40:43], v[32:35], v[72:87]
    ds_read_b128 v[12:15], v6 offset:16384
    ds_read_b128 v[16:19], v6 offset:20480
    v_mfma_f32_32x32x16_bf16 v[88:103], v[40:43], v[36:39], v[88:103]
    ds_read_b64_tr_b16 v[20:21], v8 offset:12288
    v_mfma_f32_32x32x16_bf16 v[104:119], v[44:47], v[32:35], v[104:119]
    ds_read_b64_tr_b16 v[22:23], v8 offset:12800
    v_mfma_f32_32x32x16_bf16 v[120:135], v[44:47], v[36:39], v[120:135]
    ds_read_b64_tr_b16 v[24:25], v8 offset:36864
    ds_read_b64_tr_b16 v[26:27], v8 offset:37376
    v_mfma_f32_32x32x16_bf16 v[136:151], v[48:51], v[32:35], v[136:151]
    ds_read_b64_tr_b16 v[28:29], v9 offset:6144
    v_mfma_f32_32x32x16_bf16 v[152:167], v[48:51], v[36:39], v[152:167]
    ds_read_b64_tr_b16 v[30:31], v9 offset:6400
    s_waitcnt lgkmcnt(8)
    v_mfma_f32_32x32x16_bf16 v[72:87], v[60:63], v[52:55], v[72:87]
    ds_read_b32 v11, v10 offset:4
    v_mfma_f32_32x32x16_bf16 v[88:103], v[60:63], v[56:59], v[88:103]
    ds_read_b128 v[32:35], v7 offset:16384
    ds_read_b128 v[36:39], v7 offset:20480
    v_mfma_f32_32x32x16_bf16 v[104:119], v[64:67], v[52:55], v[104:119]
    ds_read_b64_tr_b16 v[40:41], v8 offset:14336
    ds_read_b64_tr_b16 v[42:43], v8 offset:14848
    v_mfma_f32_32x32x16_bf16 v[120:135], v[64:67], v[56:59], v[120:135]
    ds_read_b64_tr_b16 v[44:45], v8 offset:38912
    v_mfma_f32_32x32x16_bf16 v[136:151], v[68:71], v[52:55], v[136:151]
    ds_read_b64_tr_b16 v[46:47], v8 offset:39424
    ds_read_b64_tr_b16 v[48:49], v9 offset:7168
    v_mfma_f32_32x32x16_bf16 v[152:167], v[68:71], v[56:59], v[152:167]
    ds_read_b64_tr_b16 v[50:51], v9 offset:7424
    s_waitcnt lgkmcnt(8)
    v_readfirstlane_b32 s38, v11
    s_add_u32 s47, s47, 1
    v_mfma_f32_32x32x16_bf16 v[72:87], v[20:23], v[12:15], v[72:87]
    s_cmp_eq_u32 s38, 4
    s_cbranch_scc1 k_sk_68
    s_waitcnt lgkmcnt(0)
    s_mov_b64 exec, 1
    ds_add_u32 v10, v2 offset:64
    s_mov_b64 exec, -1
k_w_69:
    ds_read_b32 v3, v10 offset:4
    s_waitcnt lgkmcnt(0)
    v_readfirstlane_b32 s37, v3
    s_add_u32 s35, s35, 1
    s_cmp_eq_u32 s37, 4
    s_cbranch_scc1 k_w_69_x
    s_cmp_lt_u32 s35, 2097152
    s_cbranch_scc1 k_w_69
k_w_69_x:
    v_mfma_f32_32x32x16_bf16 v[88:103], v[20:23], v[16:19], v[88:103]
    ds_read_b128 v[52:55], v4 offset:32768
    ds_read_b128 v[56:59], v4 offset:36864
    v_mfma_f32_32x32x16_bf16 v[104:119], v[24:27], v[12:15], v[104:119]
    ds_read_b64_tr_b16 v[60:61], v8 offset:16384
    ds_read_b64_tr_b16 v[62:63], v8 offset:16896
    v_mfma_f32_32x32x16_bf16 v[120:135], v[24:27], v[16:19], v[120:135]
    ds_read_b64_tr_b16 v[64:65], v8 offset:40960
    v_mfma_f32_32x32x16_bf16 v[136:151], v[28:31], v[12:15], v[136:151]
    ds_read_b64_tr_b16 v[66:67], v8 offset:41472
    ds_read_b64_tr_b16 v[68:69], v9 offset:8192
    v_mfma_f32_32x32x16_bf16 v[152:167], v[28:31], v[16:19], v[152:167]
    ds_read_b64_tr_b16 v[70:71], v9 offset:8448
    s_branch k_jn_70
k_sk_68:
    ds_read_b128 v[52:55], v4 offset:32768
    ds_read_b128 v[56:59], v4 offset:36864
    v_mfma_f32_32x32x16_bf16 v[88:103], v[20:23], v[16:19], v[88:103]
    ds_read_b64_tr_b16 v[60:61], v8 offset:16384
    ds_read_b64_tr_b16 v[62:63], v8 offset:16896
    v_mfma_f32_32x32x16_bf16 v[104:119], v[24:27], v[12:15], v[104:119]
    s_waitcnt lgkmcnt(4)
    s_mov_b64 exec, 1
    ds_add_u32 v10, v2 offset:64
    s_mov_b64 exec, -1
    v_mfma_f32_32x32x16_bf16 v[120:135], v[24:27], v[16:19], v[120:135]
    ds_read_b64_tr_b16 v[64:65], v8 offset:40960
    ds_read_b64_tr_b16 v[66:67], v8 offset:41472
    v_mfma_f32_32x32x16_bf16 v[136:151], v[28:31], v[12:15], v[136:151]
    ds_read_b64_tr_b16 v[68:69], v9 offset:8192
    ds_read_b64_tr_b16 v[70:71], v9 offset:8448
    v_mfma_f32_32x32x16_bf16 v[152:167], v[28:31], v[16:19], v[152:167]
k_jn_70:
    v_add_u32 v10, 4, v10
    v_mfma_f32_32x32x16_bf16 v[72:87], v[40:43], v[32:35], v[72:87]
    ds_read_b128 v[12:15], v5 offset:32768
    ds_read_b128 v[16:19], v5 offset:36864
    v_mfma_f32_32x32x16_bf16 v[88:103], v[40:43], v[36:39], v[88:103]
    ds_read_b64_tr_b16 v[20:21], v8 offset:18432
    v_mfma_f32_32x32x16_bf16 v[104:119], v[44:47], v[32:35], v[104:119]
    ds_read_b64_tr_b16 v[22:23], v8 offset:18944
    v_mfma_f32_32x32x16_bf16 v[120:135], v[44:47], v[36:39], v[120:135]
    ds_read_b64_tr_b16 v[24:25], v8 offset:43008
    ds_read_b64_tr_b16 v[26:27], v8 offset:43520
    v_mfma_f32_32x32x16_bf16 v[136:151], v[48:51], v[32:35], v[136:151]
    ds_read_b64_tr_b16 v[28:29], v9 offset:9216
    v_mfma_f32_32x32x16_bf16 v[152:167], v[48:51], v[36:39], v[152:167]
    ds_read_b64_tr_b16 v[30:31], v9 offset:9472
    s_waitcnt lgkmcnt(8)
    v_mfma_f32_32x32x16_bf16 v[72:87], v[60:63], v[52:55], v[72:87]
    ds_read_b128 v[32:35], v6 offset:32768
    ds_read_b128 v[36:39], v6 offset:36864
    v_mfma_f32_32x32x16_bf16 v[88:103], v[60:63], v[56:59], v[88:103]
    ds_read_b64_tr_b16 v[40:41], v8 offset:20480
    v_mfma_f32_32x32x16_bf16 v[104:119], v[64:67], v[52:55], v[104:119]
    ds_read_b64_tr_b16 v[42:43], v8 offset:20992
    v_mfma_f32_32x32x16_bf16 v[120:135], v[64:67], v[56:59], v[120:135]
    ds_read_b64_tr_b16 v[44:45], v8 offset:45056
    ds_read_b64_tr_b16 v[46:47], v8 offset:45568
    v_mfma_f32_32x32x16_bf16 v[136:151], v[68:71], v[52:55], v[136:151]
    ds_read_b64_tr_b16 v[48:49], v9 offset:10240
    v_mfma_f32_32x32x16_bf16 v[152:167], v[68:71], v[56:59], v[152:167]
    ds_read_b64_tr_b16 v[50:51], v9 offset:10496
    s_waitcnt lgkmcnt(8)
    v_mfma_f32_32x32x16_bf16 v[72:87], v[20:23], v[12:15], v[72:87]
    ds_read_b32 v11, v10 offset:4
    v_mfma_f32_32x32x16_bf16 v[88:103], v[20:23], v[16:19], v[88:103]
    ds_read_b128 v[52:55], v7 offset:32768
    ds_read_b128 v[56:59], v7 offset:36864
    v_mfma_f32_32x32x16_bf16 v[104:119], v[24:27], v[12:15], v[104:119]
    ds_read_b64_tr_b16 v[60:61], v8 offset:22528
    ds_read_b64_tr_b16 v[62:63], v8 offset:23040
    v_mfma_f32_32x32x16_bf16 v[120:135], v[24:27], v[16:19], v[120:135]
    ds_read_b64_tr_b16 v[64:65], v8 offset:47104
    v_mfma_f32_32x32x16_bf16 v[136:151], v[28:31], v[12:15], v[136:151]
    ds_read_b64_tr_b16 v[66:67], v8 offset:47616
    ds_read_b64_tr_b16 v[68:69], v9 offset:11264
    v_mfma_f32_32x32x16_bf16 v[152:167], v[28:31], v[16:19], v[152:167]
    ds_read_b64_tr_b16 v[70:71], v9 offset:11520
    s_waitcnt lgkmcnt(8)
    v_readfirstlane_b32 s38, v11
    s_add_u32 s47, s47, 1
    v_mfma_f32_32x32x16_bf16 v[72:87], v[40:43], v[32:35], v[72:87]
    s_cmp_eq_u32 s38, 4
    s_cbranch_scc1 k_sk_71
    s_waitcnt lgkmcnt(0)
    s_mov_b64 exec, 1
    ds_add_u32 v10, v2 offset:64
    s_mov_b64 exec, -1
k_w_72:
    ds_read_b32 v3, v10 offset:4
    s_waitcnt lgkmcnt(0)
    v_readfirstlane_b32 s37, v3
    s_add_u32 s35, s35, 1
    s_cmp_eq_u32 s37, 4
    s_cbranch_scc1 k_w_72_x
    s_cmp_lt_u32 s35, 2097152
    s_cbranch_scc1 k_w_72
k_w_72_x:
    v_mfma_f32_32x32x16_bf16 v[88:103], v[40:43], v[36:39], v[88:103]
    ds_read_b128 v[12:15], v4 offset:0
    ds_read_b128 v[16:19], v4 offset:4096
    v_mfma_f32_32x32x16_bf16 v[104:119], v[44:47], v[32:35], v[104:119]
    ds_read_b64_tr_b16 v[20:21], v8 offset:0
    ds_read_b64_tr_b16 v[22:23], v8 offset:512
    v_mfma_f32_32x32x16_bf16 v[120:135], v[44:47], v[36:39], v[120:135]
    ds_read_b64_tr_b16 v[24:25], v8 offset:24576
    v_mfma_f32_32x32x16_bf16 v[136:151], v[48:51], v[32:35], v[136:151]
    ds_read_b64_tr_b16 v[26:27], v8 offset:25088
    ds_read_b64_tr_b16 v[28:29], v9 offset:0
    v_mfma_f32_32x32x16_bf16 v[152:167], v[48:51], v[36:39], v[152:167]
    ds_read_b64_tr_b16 v[30:31], v9 offset:256
    s_branch k_jn_73
k_sk_71:
    ds_read_b128 v[12:15], v4 offset:0
    ds_read_b128 v[16:19], v4 offset:4096
    v_mfma_f32_32x32x16_bf16 v[88:103], v[40:43], v[36:39], v[88:103]
    ds_read_b64_tr_b16 v[20:21], v8 offset:0
    ds_read_b64_tr_b16 v[22:23], v8 offset:512
    v_mfma_f32_32x32x16_bf16 v[104:119], v[44:47], v[32:35], v[104:119]
    s_waitcnt lgkmcnt(4)
    s_mov_b64 exec, 1
    ds_add_u32 v10, v2 offset:64
    s_mov_b64 exec, -1
    v_mfma_f32_32x32x16_bf16 v[120:135], v[44:47], v[36:39], v[120:135]
    ds_read_b64_tr_b16 v[24:25], v8 offset:24576
    ds_read_b64_tr_b16 v[26:27], v8 offset:25088
    v_mfma_f32_32x32x16_bf16 v[136:151], v[48:51], v[32:35], v[136:151]
    ds_read_b64_tr_b16 v[28:29], v9 offset:0
    ds_read_b64_tr_b16 v[30:31], v9 offset:256
    v_mfma_f32_32x32x16_bf16 v[152:167], v[48:51], v[36:39], v[152:167]
k_jn_73:
    v_add_u32 v10, 4, v10
    v_mfma_f32_32x32x16_bf16 v[72:87], v[60:63], v[52:55], v[72:87]
    ds_read_b128 v[32:35], v5 offset:0
    ds_read_b128 v[36:39], v5 offset:4096
    v_mfma_f32_32x32x16_bf16 v[88:103], v[60:63], v[56:59], v[88:103]
    ds_read_b64_tr_b16 v[40:41], v8 offset:2048
    v_mfma_f32_32x32x16_bf16 v[104:119], v[64:67], v[52:55], v[104:119]
    ds_read_b64_tr_b16 v[42:43], v8 offset:2560
    v_mfma_f32_32x32x16_bf16 v[120:135], v[64:67], v[56:59], v[120:135]
    ds_read_b64_tr_b16 v[44:45], v8 offset:26624
    ds_read_b64_tr_b16 v[46:47], v8 offset:27136
    v_mfma_f32_32x32x16_bf16 v[136:151], v[68:71], v[52:55], v[136:151]
    ds_read_b64_tr_b16 v[48:49], v9 offset:1024
    v_mfma_f32_32x32x16_bf16 v[152:167], v[68:71], v[56:59], v[152:167]
    ds_read_b64_tr_b16 v[50:51], v9 offset:1280
k_gb0:
    s_waitcnt lgkmcnt(8)
    v_mfma_f32_32x32x16_bf16 v[72:87], v[20:23], v[12:15], v[72:87]
    ds_read_b128 v[52:55], v6 offset:0
    ds_read_b128 v[56:59], v6 offset:4096
    v_mfma_f32_32x32x16_bf16 v[88:103], v[20:23], v[16:19], v[88:103]
    ds_read_b64_tr_b16 v[60:61], v8 offset:4096
    v_mfma_f32_32x32x16_bf16 v[104:119], v[24:27], v[12:15], v[104:119]
    ds_read_b64_tr_b16 v[62:63], v8 offset:4608
    v_mfma_f32_32x32x16_bf16 v[120:135], v[24:27], v[16:19], v[120:135]
    ds_read_b64_tr_b16 v[64:65], v8 offset:28672
    ds_read_b64_tr_b16 v[66:67], v8 offset:29184
    v_mfma_f32_32x32x16_bf16 v[136:151], v[28:31], v[12:15], v[136:151]
    ds_read_b64_tr_b16 v[68:69], v9 offset:2048
    v_mfma_f32_32x32x16_bf16 v[152:167], v[28:31], v[16:19], v[152:167]
    ds_read_b64_tr_b16 v[70:71], v9 offset:2304
    s_waitcnt lgkmcnt(8)
    v_mfma_f32_32x32x16_bf16 v[72:87], v[40:43], v[32:35], v[72:87]
    ds_read_b32 v11, v10 offset:4
    v_mfma_f32_32x32x16_bf16 v[88:103], v[40:43], v[36:39], v[88:103]
    ds_read_b128 v[12:15], v7 offset:0
    ds_read_b128 v[16:19], v7 offset:4096
    v_mfma_f32_32x32x16_bf16 v[104:119], v[44:47], v[32:35], v[104:119]
    ds_read_b64_tr_b16 v[20:21], v8 offset:6144
    ds_read_b64_tr_b16 v[22:23], v8 offset:6656
    v_mfma_f32_32x32x16_bf16 v[120:135], v[44:47], v[36:39], v[120:135]
    ds_read_b64_tr_b16 v[24:25], v8 offset:30720
    v_mfma_f32_32x32x16_bf16 v[136:151], v[48:51], v[32:35], v[136:151]
    ds_read_b64_tr_b16 v[26:27], v8 offset:31232
    ds_read_b64_tr_b16 v[28:29], v9 offset:3072
    v_mfma_f32_32x32x16_bf16 v[152:167], v[48:51], v[36:39], v[152:167]
    ds_read_b64_tr_b16 v[30:31], v9 offset:3328
    s_waitcnt lgkmcnt(8)
    v_readfirstlane_b32 s38, v11
    s_add_u32 s47, s47, 1
    v_mfma_f32_32x32x16_bf16 v[72:87], v[60:63], v[52:55], v[72:87]
    s_cmp_eq_u32 s47, 10
    s_cbranch_scc1 k_glast
    s_cmp_eq_u32 s38, 4
    s_cbranch_scc1 k_sk_74
    s_waitcnt lgkmcnt(0)
    s_mov_b64 exec, 1
    ds_add_u32 v10, v2 offset:64
    s_mov_b64 exec, -1
k_w_75:
    ds_read_b32 v3, v10 offset:4
    s_waitcnt lgkmcnt(0)
    v_readfirstlane_b32 s37, v3
    s_add_u32 s35, s35, 1
    s_cmp_eq_u32 s37, 4
    s_cbranch_scc1 k_w_75_x
    s_cmp_lt_u32 s35, 2097152
    s_cbranch_scc1 k_w_75
k_w_75_x:
    v_mfma_f32_32x32x16_bf16 v[88:103], v[60:63], v[56:59], v[88:103]
    ds_read_b128 v[32:35], v4 offset:16384
    ds_read_b128 v[36:39], v4 offset:20480
    v_mfma_f32_32x32x16_bf16 v[104:119], v[64:67], v[52:55], v[104:119]
    ds_read_b64_tr_b16 v[40:41], v8 offset:8192
    ds_read_b64_tr_b16 v[42:43], v8 offset:8704
    v_mfma_f32_32x32x16_bf16 v[120:135], v[64:67], v[56:59], v[120:135]
    ds_read_b64_tr_b16 v[44:45], v8 offset:32768
    v_mfma_f32_32x32x16_bf16 v[136:151], v[68:71], v[52:55], v[136:151]
    ds_read_b64_tr_b16 v[46:47], v8 offset:33280
    ds_read_b64_tr_b16 v[48:49], v9 offset:4096
    v_mfma_f32_32x32x16_bf16 v[152:167], v[68:71], v[56:59], v[152:167]
    ds_read_b64_tr_b16 v[50:51], v9 offset:4352
    s_branch k_jn_76
k_sk_74:
    ds_read_b128 v[32:35], v4 offset:16384
    ds_read_b128 v[36:39], v4 offset:20480
    v_mfma_f32_32x32x16_bf16 v[88:103], v[60:63], v[56:59], v[88:103]
    ds_read_b64_tr_b16 v[40:41], v8 offset:8192
    ds_read_b64_tr_b16 v[42:43], v8 offset:8704
    v_mfma_f32_32x32x16_bf16 v[104:119], v[64:67], v[52:55], v[104:119]
    s_waitcnt lgkmcnt(4)
    s_mov_b64 exec, 1
    ds_add_u32 v10, v2 offset:64
    s_mov_b64 exec, -1
    v_mfma_f32_32x32x16_bf16 v[120:135], v[64:67], v[56:59], v[120:135]
    ds_read_b64_tr_b16 v[44:45], v8 offset:32768
    ds_read_b64_tr_b16 v[46:47], v8 offset:33280
    v_mfma_f32_32x32x16_bf16 v[136:151], v[68:71], v[52:55], v[136:151]
    ds_read_b64_tr_b16 v[48:49], v9 offset:4096
    ds_read_b64_tr_b16 v[50:51], v9 offset:4352
    v_mfma_f32_32x32x16_bf16 v[152:167], v[68:71], v[56:59], v[152:167]
k_jn_76:
    v_add_u32 v10, 4, v10
    v_mfma_f32_32x32x16_bf16 v[72:87], v[20:23], v[12:15], v[72:87]
    ds_read_b128 v[52:55], v5 offset:16384
    ds_read_b128 v[56:59], v5 offset:20480
    v_mfma_f32_32x32x16_bf16 v[88:103], v[20:23], v[16:19], v[88:103]
    ds_read_b64_tr_b16 v[60:61], v8 offset:10240
    v_mfma_f32_32x32x16_bf16 v[104:119], v[24:27], v[12:15], v[104:119]
    ds_read_b64_tr_b16 v[62:63], v8 offset:10752
    v_mfma_f32_32x32x16_bf16 v[120:135], v[24:27], v[16:19], v[120:135]
    ds_read_b64_tr_b16 v[64:65], v8 offset:34816
    ds_read_b64_tr_b16 v[66:67], v8 offset:35328
    v_mfma_f32_32x32x16_bf16 v[136:151], v[28:31], v[12:15], v[136:151]
    ds_read_b64_tr_b16 v[68:69], v9 offset:5120
    v_mfma_f32_32x32x16_bf16 v[152:167], v[28:31], v[16:19], v[152:167]
    ds_read_b64_tr_b16 v[70:71], v9 offset:5376
    s_branch k_gloop
k_glast:
    v_mfma_f32_32x32x16_bf16 v[88:103], v[60:63], v[56:59], v[88:103]
    v_mfma_f32_32x32x16_bf16 v[104:119], v[64:67], v[52:55], v[104:119]
    s_waitcnt lgkmcnt(0)
    s_mov_b64 exec, 1
    ds_add_u32 v10, v2 offset:64
    s_mov_b64 exec, -1
    v_mfma_f32_32x32x16_bf16 v[120:135], v[64:67], v[56:59], v[120:135]
    v_mfma_f32_32x32x16_bf16 v[136:151], v[68:71], v[52:55], v[136:151]
    v_mfma_f32_32x32x16_bf16 v[152:167], v[68:71], v[56:59], v[152:167]
    v_mfma_f32_32x32x16_bf16 v[72:87], v[20:23], v[12:15], v[72:87]
    v_mfma_f32_32x32x16_bf16 v[88:103], v[20:23], v[16:19], v[88:103]
    v_mfma_f32_32x32x16_bf16 v[104:119], v[24:27], v[12:15], v[104:119]
    v_mfma_f32_32x32x16_bf16 v[120:135], v[24:27], v[16:19], v[120:135]
    v_mfma_f32_32x32x16_bf16 v[136:151], v[28:31], v[12:15], v[136:151]
    v_mfma_f32_32x32x16_bf16 v[152:167], v[28:31], v[16:19], v[152:167]
    s_setprio 3
    s_and_b32 s39, s33, 1
    s_lshl_b32 s40, s42, 8
    s_add_u32 s40, s40, 161280
    v_and_b32 v52, 31, v0
    v_lshlrev_b32 v52, 3, v52
    v_add_u32 v53, s40, v52
    s_lshl_b32 s40, s42, 7
    s_add_u32 s40, s40, 162304
    v_and_b32 v54, 15, v0
    v_lshlrev_b32 v54, 3, v54
    v_bfe_u32 v55, v0, 4, 1
    v_lshlrev_b32 v55, 8, v55
    v_add3_u32 v54, v54, v55, s40
    s_lshl_b32 s40, s41, 9
    s_add_u32 s40, s40, 162816
    v_add_u32 v55, s40, v52
    v_mov_b32 v34, 0
    v_mov_b32 v35, 0
    v_mov_b32 v38, 0
    v_mov_b32 v39, 0
    v_mov_b32 v42, 0
    v_mov_b32 v43, 0
    v_mov_b32 v46, 0
    v_mov_b32 v47, 0
    v_mov_b32 v50, 0
    v_mov_b32 v51, 0
k_w_77:
    ds_read_b32 v3, v1 offset:272
    s_waitcnt lgkmcnt(0)
    v_readfirstlane_b32 s37, v3
    s_add_u32 s35, s35, 1
    s_cmp_eq_u32 s37, 4
    s_cbranch_scc1 k_w_77_x
    s_sleep 1
    s_cmp_lt_u32 s35, 2097152
    s_cbranch_scc1 k_w_77
k_w_77_x:
    ds_read_b64 v[56:57], v55
    ds_read_b64 v[58:59], v55 offset:256
    ds_read_b64 v[40:41], v53
    ds_read_b64 v[44:45], v53 offset:512
    ds_read_b64 v[48:49], v54
    v_cmp_gt_u32 vcc, 32, v0
    s_waitcnt lgkmcnt(3)
    v_cvt_pk_bf16_f32 v32, -v56, -v56
    v_cndmask_b32 v32, 0, v32, vcc
    v_and_b32 v33, 0xffff, v32
    v_cvt_pk_bf16_f32 v36, -v58, -v58
    v_cndmask_b32 v36, 0, v36, vcc
    v_and_b32 v37, 0xffff, v36
    s_waitcnt lgkmcnt(0)
    v_mfma_f32_32x32x16_bf16 v[72:87], v[40:43], v[32:35], v[72:87]
    v_mfma_f32_32x32x16_bf16 v[88:103], v[40:43], v[36:39], v[88:103]
    v_mfma_f32_32x32x16_bf16 v[104:119], v[44:47], v[32:35], v[104:119]
    v_mfma_f32_32x32x16_bf16 v[120:135], v[44:47], v[36:39], v[120:135]
    v_mfma_f32_32x32x16_bf16 v[136:151], v[48:51], v[32:35], v[136:151]
    v_mfma_f32_32x32x16_bf16 v[152:167], v[48:51], v[36:39], v[152:167]
    v_rcp_f32 v60, v57
    v_mul_f32 v64, v57, v57
    v_mul_f32 v60, 0xbfb8aa3b, v60
    v_rcp_f32 v62, v59
    v_mul_f32 v66, v59, v59
    v_mul_f32 v62, 0xbfb8aa3b, v62
    s_lshl_b32 s40, s32, 3
    s_lshl_b32 s43, s41, 2
    s_add_u32 s40, s40, s43
    s_mul_i32 s40, s40, 49152
    s_add_u32 s40, s40, 6291456
    s_mul_i32 s43, s33, 3
    s_add_u32 s44, s43, s39
    s_add_u32 s44, s44, s42
    s_lshl_b32 s44, s44, 10
    s_add_u32 s44, s44, s40
    s_xor_b32 s45, s39, 1
    s_lshl_b32 s45, s45, 1
    s_add_u32 s45, s45, s43
    s_lshl_b32 s45, s45, 10
    s_lshl_b32 s46, s42, 9
    s_add_u32 s45, s45, s46
    s_add_u32 s45, s45, s40
    v_bfe_u32 v4, v0, 4, 1
    v_mul_u32_u24 v4, 49152, v4
    v_lshrrev_b32 v5, 5, v0
    v_lshl_add_u32 v4, v5, 8, v4
    v_and_b32 v5, 15, v0
    v_lshl_add_u32 v4, v5, 4, v4
    v_add_u32 v5, 98304, v4
    v_mul_f32 v12, v72, v60
    v_mul_f32 v13, v73, v60
    v_mul_f32 v14, v74, v60
    v_mul_f32 v15, v75, v60
    v_mul_f32 v16, v76, v60
    v_mul_f32 v17, v77, v60
    v_mul_f32 v18, v78, v60
    v_mul_f32 v19, v79, v60
    v_exp_f32 v12, v12
    v_mul_f32 v72, v72, v104
    v_exp_f32 v13, v13
    v_mul_f32 v73, v73, v105
    v_exp_f32 v14, v14
    v_mul_f32 v74, v74, v106
    v_exp_f32 v15, v15
    v_mul_f32 v75, v75, v107
    v_exp_f32 v16, v16
    v_mul_f32 v76, v76, v108
    v_exp_f32 v17, v17
    v_mul_f32 v77, v77, v109
    v_exp_f32 v18, v18
    v_mul_f32 v78, v78, v110
    v_exp_f32 v19, v19
    v_mul_f32 v79, v79, v111
    v_fma_f32 v12, v12, v64, v64
    v_fma_f32 v13, v13, v64, v64
    v_fma_f32 v14, v14, v64, v64
    v_fma_f32 v15, v15, v64, v64
    v_fma_f32 v16, v16, v64, v64
    v_fma_f32 v17, v17, v64, v64
    v_fma_f32 v18, v18, v64, v64
    v_fma_f32 v19, v19, v64, v64
    v_rcp_f32 v12, v12
    v_rcp_f32 v13, v13
    v_rcp_f32 v14, v14
    v_rcp_f32 v15, v15
    v_rcp_f32 v16, v16
    v_rcp_f32 v17, v17
    v_rcp_f32 v18, v18
    v_rcp_f32 v19, v19
    v_mul_f32 v72, v72, v12
    v_mul_f32 v73, v73, v13
    v_mul_f32 v74, v74, v14
    v_mul_f32 v75, v75, v15
    v_mul_f32 v76, v76, v16
    v_mul_f32 v77, v77, v17
    v_mul_f32 v78, v78, v18
    v_mul_f32 v79, v79, v19
    v_cvt_pk_bf16_f32 v28, v72, v73
    v_cvt_pk_bf16_f32 v29, v74, v75
    v_cvt_pk_bf16_f32 v30, v76, v77
    v_cvt_pk_bf16_f32 v31, v78, v79
    buffer_store_dwordx4 v[28:31], v4, s[16:19], s44 offen offset:0 sc1
    v_mul_f32 v20, v80, v60
    v_mul_f32 v21, v81, v60
    v_mul_f32 v22, v82, v60
    v_mul_f32 v23, v83, v60
    v_mul_f32 v24, v84, v60
    v_mul_f32 v25, v85, v60
    v_mul_f32 v26, v86, v60
    v_mul_f32 v27, v87, v60
    v_exp_f32 v20, v20
    v_mul_f32 v80, v80, v112
    v_exp_f32 v21, v21
    v_mul_f32 v81, v81, v113
    v_exp_f32 v22, v22
    v_mul_f32 v82, v82, v114
    v_exp_f32 v23, v23
    v_mul_f32 v83, v83, v115
    v_exp_f32 v24, v24
    v_mul_f32 v84, v84, v116
    v_exp_f32 v25, v25
    v_mul_f32 v85, v85, v117
    v_exp_f32 v26, v26
    v_mul_f32 v86, v86, v118
    v_exp_f32 v27, v27
    v_mul_f32 v87, v87, v119
    v_fma_f32 v20, v20, v64, v64
    v_fma_f32 v21, v21, v64, v64
    v_fma_f32 v22, v22, v64, v64
    v_fma_f32 v23, v23, v64, v64
    v_fma_f32 v24, v24, v64, v64
    v_fma_f32 v25, v25, v64, v64
    v_fma_f32 v26, v26, v64, v64
    v_fma_f32 v27, v27, v64, v64
    v_rcp_f32 v20, v20
    v_rcp_f32 v21, v21
    v_rcp_f32 v22, v22
    v_rcp_f32 v23, v23
    v_rcp_f32 v24, v24
    v_rcp_f32 v25, v25
    v_rcp_f32 v26, v26
    v_rcp_f32 v27, v27
    v_mul_f32 v80, v80, v20
    v_mul_f32 v81, v81, v21
    v_mul_f32 v82, v82, v22
    v_mul_f32 v83, v83, v23
    v_mul_f32 v84, v84, v24
    v_mul_f32 v85, v85, v25
    v_mul_f32 v86, v86, v26
    v_mul_f32 v87, v87, v27
    v_cvt_pk_bf16_f32 v68, v80, v81
    v_cvt_pk_bf16_f32 v69, v82, v83
    v_cvt_pk_bf16_f32 v70, v84, v85
    v_cvt_pk_bf16_f32 v71, v86, v87
    buffer_store_dwordx4 v[68:71], v4, s[16:19], s44 offen offset:512 sc1
    v_mul_f32 v12, v136, v60
    v_mul_f32 v13, v137, v60
    v_mul_f32 v14, v138, v60
    v_mul_f32 v15, v139, v60
    v_mul_f32 v16, v140, v60
    v_mul_f32 v17, v141, v60
    v_mul_f32 v18, v142, v60
    v_mul_f32 v19, v143, v60
    v_exp_f32 v12, v12
    v_mul_f32 v136, v136, v144
    v_exp_f32 v13, v13
    v_mul_f32 v137, v137, v145
    v_exp_f32 v14, v14
    v_mul_f32 v138, v138, v146
    v_exp_f32 v15, v15
    v_mul_f32 v139, v139, v147
    v_exp_f32 v16, v16
    v_mul_f32 v140, v140, v148
    v_exp_f32 v17, v17
    v_mul_f32 v141, v141, v149
    v_exp_f32 v18, v18
    v_mul_f32 v142, v142, v150
    v_exp_f32 v19, v19
    v_mul_f32 v143, v143, v151
    v_fma_f32 v12, v12, v64, v64
    v_fma_f32 v13, v13, v64, v64
    v_fma_f32 v14, v14, v64, v64
    v_fma_f32 v15, v15, v64, v64
    v_fma_f32 v16, v16, v64, v64
    v_fma_f32 v17, v17, v64, v64
    v_fma_f32 v18, v18, v64, v64
    v_fma_f32 v19, v19, v64, v64
    v_rcp_f32 v12, v12
    v_rcp_f32 v13, v13
    v_rcp_f32 v14, v14
    v_rcp_f32 v15, v15
    v_rcp_f32 v16, v16
    v_rcp_f32 v17, v17
    v_rcp_f32 v18, v18
    v_rcp_f32 v19, v19
    v_mul_f32 v136, v136, v12
    v_mul_f32 v137, v137, v13
    v_mul_f32 v138, v138, v14
    v_mul_f32 v139, v139, v15
    v_mul_f32 v140, v140, v16
    v_mul_f32 v141, v141, v17
    v_mul_f32 v142, v142, v18
    v_mul_f32 v143, v143, v19
    v_cvt_pk_bf16_f32 v28, v136, v137
    v_cvt_pk_bf16_f32 v29, v138, v139
    v_cvt_pk_bf16_f32 v30, v140, v141
    v_cvt_pk_bf16_f32 v31, v142, v143
    buffer_store_dwordx4 v[28:31], v4, s[16:19], s45 offen offset:0 sc1
    v_mul_f32 v20, v88, v62
    v_mul_f32 v21, v89, v62
    v_mul_f32 v22, v90, v62
    v_mul_f32 v23, v91, v62
    v_mul_f32 v24, v92, v62
    v_mul_f32 v25, v93, v62
    v_mul_f32 v26, v94, v62
    v_mul_f32 v27, v95, v62
    v_exp_f32 v20, v20
    v_mul_f32 v88, v88, v120
    v_exp_f32 v21, v21
    v_mul_f32 v89, v89, v121
    v_exp_f32 v22, v22
    v_mul_f32 v90, v90, v122
    v_exp_f32 v23, v23
    v_mul_f32 v91, v91, v123
    v_exp_f32 v24, v24
    v_mul_f32 v92, v92, v124
    v_exp_f32 v25, v25
    v_mul_f32 v93, v93, v125
    v_exp_f32 v26, v26
    v_mul_f32 v94, v94, v126
    v_exp_f32 v27, v27
    v_mul_f32 v95, v95, v127
    v_fma_f32 v20, v20, v66, v66
    v_fma_f32 v21, v21, v66, v66
    v_fma_f32 v22, v22, v66, v66
    v_fma_f32 v23, v23, v66, v66
    v_fma_f32 v24, v24, v66, v66
    v_fma_f32 v25, v25, v66, v66
    v_fma_f32 v26, v26, v66, v66
    v_fma_f32 v27, v27, v66, v66
    v_rcp_f32 v20, v20
    v_rcp_f32 v21, v21
    v_rcp_f32 v22, v22
    v_rcp_f32 v23, v23
    v_rcp_f32 v24, v24
    v_rcp_f32 v25, v25
    v_rcp_f32 v26, v26
    v_rcp_f32 v27, v27
    v_mul_f32 v88, v88, v20
    v_mul_f32 v89, v89, v21
    v_mul_f32 v90, v90, v22
    v_mul_f32 v91, v91, v23
    v_mul_f32 v92, v92, v24
    v_mul_f32 v93, v93, v25
    v_mul_f32 v94, v94, v26
    v_mul_f32 v95, v95, v27
    v_cvt_pk_bf16_f32 v68, v88, v89
    v_cvt_pk_bf16_f32 v69, v90, v91
    v_cvt_pk_bf16_f32 v70, v92, v93
    v_cvt_pk_bf16_f32 v71, v94, v95
    buffer_store_dwordx4 v[68:71], v5, s[16:19], s44 offen offset:0 sc1
    s_load_dwordx4 s[60:63], s[82:83], s55 glc
    v_lshlrev_b32 v7, 4, v0
    v_mul_f32 v12, v96, v62
    v_mul_f32 v13, v97, v62
    v_mul_f32 v14, v98, v62
    v_mul_f32 v15, v99, v62
    v_mul_f32 v16, v100, v62
    v_mul_f32 v17, v101, v62
    v_mul_f32 v18, v102, v62
    v_mul_f32 v19, v103, v62
    v_exp_f32 v12, v12
    v_mul_f32 v96, v96, v128
    v_exp_f32 v13, v13
    v_mul_f32 v97, v97, v129
    v_exp_f32 v14, v14
    v_mul_f32 v98, v98, v130
    v_exp_f32 v15, v15
    v_mul_f32 v99, v99, v131
    v_exp_f32 v16, v16
    v_mul_f32 v100, v100, v132
    v_exp_f32 v17, v17
    v_mul_f32 v101, v101, v133
    v_exp_f32 v18, v18
    v_mul_f32 v102, v102, v134
    v_exp_f32 v19, v19
    v_mul_f32 v103, v103, v135
    v_fma_f32 v12, v12, v66, v66
    v_fma_f32 v13, v13, v66, v66
    v_fma_f32 v14, v14, v66, v66
    v_fma_f32 v15, v15, v66, v66
    v_fma_f32 v16, v16, v66, v66
    v_fma_f32 v17, v17, v66, v66
    v_fma_f32 v18, v18, v66, v66
    v_fma_f32 v19, v19, v66, v66
    v_rcp_f32 v12, v12
    v_rcp_f32 v13, v13
    v_rcp_f32 v14, v14
    v_rcp_f32 v15, v15
    v_rcp_f32 v16, v16
    v_rcp_f32 v17, v17
    v_rcp_f32 v18, v18
    v_rcp_f32 v19, v19
    v_mul_f32 v96, v96, v12
    v_mul_f32 v97, v97, v13
    v_mul_f32 v98, v98, v14
    v_mul_f32 v99, v99, v15
    v_mul_f32 v100, v100, v16
    v_mul_f32 v101, v101, v17
    v_mul_f32 v102, v102, v18
    v_mul_f32 v103, v103, v19
    v_cvt_pk_bf16_f32 v28, v96, v97
    v_cvt_pk_bf16_f32 v29, v98, v99
    v_cvt_pk_bf16_f32 v30, v100, v101
    v_cvt_pk_bf16_f32 v31, v102, v103
    buffer_store_dwordx4 v[28:31], v5, s[16:19], s44 offen offset:512 sc1
    v_mul_f32 v20, v152, v62
    v_mul_f32 v21, v153, v62
    v_mul_f32 v22, v154, v62
    v_mul_f32 v23, v155, v62
    v_mul_f32 v24, v156, v62
    v_mul_f32 v25, v157, v62
    v_mul_f32 v26, v158, v62
    v_mul_f32 v27, v159, v62
    v_exp_f32 v20, v20
    v_mul_f32 v152, v152, v160
    v_exp_f32 v21, v21
    v_mul_f32 v153, v153, v161
    v_exp_f32 v22, v22
    v_mul_f32 v154, v154, v162
    v_exp_f32 v23, v23
    v_mul_f32 v155, v155, v163
    v_exp_f32 v24, v24
    v_mul_f32 v156, v156, v164
    v_exp_f32 v25, v25
    v_mul_f32 v157, v157, v165
    v_exp_f32 v26, v26
    v_mul_f32 v158, v158, v166
    v_exp_f32 v27, v27
    v_mul_f32 v159, v159, v167
    v_fma_f32 v20, v20, v66, v66
    v_fma_f32 v21, v21, v66, v66
    v_fma_f32 v22, v22, v66, v66
    v_fma_f32 v23, v23, v66, v66
    v_fma_f32 v24, v24, v66, v66
    v_fma_f32 v25, v25, v66, v66
    v_fma_f32 v26, v26, v66, v66
    v_fma_f32 v27, v27, v66, v66
    v_rcp_f32 v20, v20
    v_rcp_f32 v21, v21
    v_rcp_f32 v22, v22
    v_rcp_f32 v23, v23
    v_rcp_f32 v24, v24
    v_rcp_f32 v25, v25
    v_rcp_f32 v26, v26
    v_rcp_f32 v27, v27
    v_mul_f32 v152, v152, v20
    v_mul_f32 v153, v153, v21
    v_mul_f32 v154, v154, v22
    v_mul_f32 v155, v155, v23
    v_mul_f32 v156, v156, v24
    v_mul_f32 v157, v157, v25
    v_mul_f32 v158, v158, v26
    v_mul_f32 v159, v159, v27
    v_cvt_pk_bf16_f32 v68, v152, v153
    v_cvt_pk_bf16_f32 v69, v154, v155
    v_cvt_pk_bf16_f32 v70, v156, v157
    v_cvt_pk_bf16_f32 v71, v158, v159
    buffer_store_dwordx4 v[68:71], v5, s[16:19], s45 offen offset:0 sc1
    s_waitcnt lgkmcnt(0)
    s_cmp_eq_u32 s63, 2
    s_cbranch_scc0 k_g2late
    s_add_u32 s54, s64, 9216
    buffer_load_dwordx4 v[20:23], v7, s[16:19], s54 offen sc1
    s_add_u32 s54, s65, 9216
    buffer_load_dwordx4 v[24:27], v7, s[16:19], s54 offen sc1
    s_add_u32 s54, s66, 9216
    buffer_load_dwordx4 v[28:31], v7, s[16:19], s54 offen sc1
    s_add_u32 s54, s67, 9216
    buffer_load_dwordx4 v[32:35], v7, s[16:19], s54 offen sc1
    s_add_u32 s54, s64, 10240
    buffer_load_dwordx4 v[36:39], v7, s[16:19], s54 offen sc1
    s_add_u32 s54, s65, 10240
    buffer_load_dwordx4 v[40:43], v7, s[16:19], s54 offen sc1
    s_add_u32 s54, s66, 10240
    buffer_load_dwordx4 v[44:47], v7, s[16:19], s54 offen sc1
    s_add_u32 s54, s67, 10240
    buffer_load_dwordx4 v[48:51], v7, s[16:19], s54 offen sc1
    s_add_u32 s54, s64, 11264
    buffer_load_dwordx4 v[52:55], v7, s[16:19], s54 offen sc1
    s_add_u32 s54, s65, 11264
    buffer_load_dwordx4 v[56:59], v7, s[16:19], s54 offen sc1
    s_add_u32 s54, s66, 11264
    buffer_load_dwordx4 v[60:63], v7, s[16:19], s54 offen sc1
    s_add_u32 s54, s67, 11264
    buffer_load_dwordx4 v[64:67], v7, s[16:19], s54 offen sc1
    s_lshl_b32 s37, s3, 12
    v_add_u32 v4, s37, v7
    s_lshl_b32 s37, s3, 11
    s_add_u32 s37, s37, 49152
    v_add_u32 v5, s37, v7
    s_lshl_b32 s37, s3, 10
    s_add_u32 s37, s37, 98304
    v_add_u32 v6, s37, v7
    s_lshl_b32 s37, s3, 2
    v_add_u32 v10, s37, v1
    s_sub_u32 s37, s3, 1
    s_and_b32 s37, s37, 3
    s_lshl_b32 s38, s37, 12
    v_add_u32 v17, s38, v7
    s_sub_u32 s37, s3, 2
    s_and_b32 s37, s37, 3
    s_lshl_b32 s38, s37, 12
    v_add_u32 v18, s38, v7
    s_sub_u32 s37, s3, 3
    s_and_b32 s37, s37, 3
    s_lshl_b32 s38, s37, 12
    v_add_u32 v19, s38, v7
    s_lshl_b32 s38, s37, 11
    s_add_u32 s38, s38, 49152
    v_add_u32 v8, s38, v7
    v_and_b32 v15, 15, v0
    v_mul_u32_u24 v15, 1280, v15
    v_lshrrev_b32 v9, 4, v0
    v_lshl_add_u32 v16, v9, 3, v15
    v_lshl_add_u32 v15, v9, 4, v15
    s_waitcnt vmcnt(12)
    s_mov_b32 s51, 1
    s_atomic_add s51, s[82:83], s59 glc
    s_branch k_g2go
k_g2late:
    s_lshl_b32 s37, s3, 12
    v_add_u32 v4, s37, v7
    s_lshl_b32 s37, s3, 11
    s_add_u32 s37, s37, 49152
    v_add_u32 v5, s37, v7
    s_lshl_b32 s37, s3, 10
    s_add_u32 s37, s37, 98304
    v_add_u32 v6, s37, v7
    s_lshl_b32 s37, s3, 2
    v_add_u32 v10, s37, v1
    s_sub_u32 s37, s3, 1
    s_and_b32 s37, s37, 3
    s_lshl_b32 s38, s37, 12
    v_add_u32 v17, s38, v7
    s_sub_u32 s37, s3, 2
    s_and_b32 s37, s37, 3
    s_lshl_b32 s38, s37, 12
    v_add_u32 v18, s38, v7
    s_sub_u32 s37, s3, 3
    s_and_b32 s37, s37, 3
    s_lshl_b32 s38, s37, 12
    v_add_u32 v19, s38, v7
    s_lshl_b32 s38, s37, 11
    s_add_u32 s38, s38, 49152
    v_add_u32 v8, s38, v7
    v_and_b32 v15, 15, v0
    v_mul_u32_u24 v15, 1280, v15
    v_lshrrev_b32 v9, 4, v0
    v_lshl_add_u32 v16, v9, 3, v15
    v_lshl_add_u32 v15, v9, 4, v15
    s_waitcnt vmcnt(0)
    s_mov_b32 s51, 1
    s_atomic_add s51, s[82:83], s59 glc
k_h_78:
    s_load_dwordx4 s[60:63], s[82:83], s55 glc
    s_add_u32 s35, s35, 1
    s_waitcnt lgkmcnt(0)
    s_cmp_eq_u32 s63, 2
    s_cbranch_scc1 k_h_78_x
    s_cmp_lt_u32 s35, 2097152
    s_cbranch_scc1 k_h_78
k_h_78_x:
    s_add_u32 s54, s64, 9216
    buffer_load_dwordx4 v[20:23], v7, s[16:19], s54 offen sc1
    s_add_u32 s54, s65, 9216
    buffer_load_dwordx4 v[24:27], v7, s[16:19], s54 offen sc1
    s_add_u32 s54, s66, 9216
    buffer_load_dwordx4 v[28:31], v7, s[16:19], s54 offen sc1
    s_add_u32 s54, s67, 9216
    buffer_load_dwordx4 v[32:35], v7, s[16:19], s54 offen sc1
    s_add_u32 s54, s64, 10240
    buffer_load_dwordx4 v[36:39], v7, s[16:19], s54 offen sc1
    s_add_u32 s54, s65, 10240
    buffer_load_dwordx4 v[40:43], v7, s[16:19], s54 offen sc1
    s_add_u32 s54, s66, 10240
    buffer_load_dwordx4 v[44:47], v7, s[16:19], s54 offen sc1
    s_add_u32 s54, s67, 10240
    buffer_load_dwordx4 v[48:51], v7, s[16:19], s54 offen sc1
    s_add_u32 s54, s64, 11264
    buffer_load_dwordx4 v[52:55], v7, s[16:19], s54 offen sc1
    s_add_u32 s54, s65, 11264
    buffer_load_dwordx4 v[56:59], v7, s[16:19], s54 offen sc1
    s_add_u32 s54, s66, 11264
    buffer_load_dwordx4 v[60:63], v7, s[16:19], s54 offen sc1
    s_add_u32 s54, s67, 11264
    buffer_load_dwordx4 v[64:67], v7, s[16:19], s54 offen sc1
k_g2go:
    s_setprio 2
k_w_79:
    ds_read_b32 v3, v10 offset:128
    s_waitcnt lgkmcnt(0)
    v_readfirstlane_b32 s37, v3
    s_add_u32 s35, s35, 1
    s_cmp_eq_u32 s37, 1
    s_cbranch_scc1 k_w_79_x
    s_cmp_lt_u32 s35, 2097152
    s_cbranch_scc1 k_w_79
k_w_79_x:
    ds_read_b128 v[68:71], v5 offset:8192
    ds_read_b128 v[72:75], v5 offset:9216
    ds_read_b128 v[76:79], v5 offset:32768
    ds_read_b128 v[80:83], v5 offset:33792
    ds_read_b128 v[84:87], v6 offset:4096
    s_waitcnt vmcnt(8)
    s_waitcnt lgkmcnt(4)
    v_mfma_f32_16x16x32_bf16 v[88:91], v[68:71], v[20:23], 0
    v_mfma_f32_16x16x32_bf16 v[108:111], v[68:71], v[24:27], 0
    v_mfma_f32_16x16x32_bf16 v[128:131], v[68:71], v[28:31], 0
    v_mfma_f32_16x16x32_bf16 v[148:151], v[68:71], v[32:35], 0
    s_waitcnt lgkmcnt(3)
    v_mfma_f32_16x16x32_bf16 v[92:95], v[72:75], v[20:23], 0
    ds_read_b128 v[68:71], v6 offset:16384
    v_mfma_f32_16x16x32_bf16 v[112:115], v[72:75], v[24:27], 0
    v_mfma_f32_16x16x32_bf16 v[132:135], v[72:75], v[28:31], 0
    ds_read_b32 v11, v10 offset:144
    v_mfma_f32_16x16x32_bf16 v[152:155], v[72:75], v[32:35], 0
    s_waitcnt lgkmcnt(4)
    v_mfma_f32_16x16x32_bf16 v[96:99], v[76:79], v[20:23], 0
    ds_read_b128 v[72:75], v4 offset:16384
    v_mfma_f32_16x16x32_bf16 v[116:119], v[76:79], v[24:27], 0
    v_mfma_f32_16x16x32_bf16 v[136:139], v[76:79], v[28:31], 0
    v_mfma_f32_16x16x32_bf16 v[156:159], v[76:79], v[32:35], 0
    s_waitcnt lgkmcnt(4)
    v_mfma_f32_16x16x32_bf16 v[100:103], v[80:83], v[20:23], 0
    ds_read_b128 v[76:79], v4 offset:17408
    v_mfma_f32_16x16x32_bf16 v[120:123], v[80:83], v[24:27], 0
    v_mfma_f32_16x16x32_bf16 v[140:143], v[80:83], v[28:31], 0
    s_waitcnt lgkmcnt(2)
    v_readfirstlane_b32 s38, v11
    v_mfma_f32_16x16x32_bf16 v[160:163], v[80:83], v[32:35], 0
    s_waitcnt lgkmcnt(4)
    v_mfma_f32_16x16x32_bf16 v[104:107], v[84:87], v[20:23], 0
    ds_read_b128 v[80:83], v4 offset:18432
    v_mfma_f32_16x16x32_bf16 v[124:127], v[84:87], v[24:27], 0
    s_mov_b64 exec, 1
    ds_add_u32 v10, v2 offset:224
    s_mov_b64 exec, -1
    v_mfma_f32_16x16x32_bf16 v[144:147], v[84:87], v[28:31], 0
    s_cmp_ge_u32 s38, 1
    s_cbranch_scc1 k_sk_80
k_w_81:
    ds_read_b32 v3, v10 offset:144
    s_waitcnt lgkmcnt(0)
    v_readfirstlane_b32 s37, v3
    s_add_u32 s35, s35, 1
    s_cmp_ge_u32 s37, 1
    s_cbranch_scc1 k_w_81_x
    s_cmp_lt_u32 s35, 2097152
    s_cbranch_scc1 k_w_81
k_w_81_x:
k_sk_80:
    v_mfma_f32_16x16x32_bf16 v[164:167], v[84:87], v[32:35], 0
    s_waitcnt vmcnt(4)
    s_cmp_eq_u32 s62, 2
    s_cbranch_scc1 k_h_82_x
k_h_82:
    s_load_dwordx4 s[60:63], s[82:83], s55 glc
    s_add_u32 s35, s35, 1
    s_waitcnt lgkmcnt(0)
    s_cmp_eq_u32 s62, 2
    s_cbranch_scc1 k_h_82_x
    s_cmp_lt_u32 s35, 2097152
    s_cbranch_scc1 k_h_82
k_h_82_x:
    s_waitcnt lgkmcnt(5)
    v_mfma_f32_16x16x32_bf16 v[88:91], v[68:71], v[36:39], v[88:91]
    ds_read_b128 v[84:87], v4 offset:19456
    v_mfma_f32_16x16x32_bf16 v[108:111], v[68:71], v[40:43], v[108:111]
    s_add_u32 s54, s64, 6144
    buffer_load_dwordx4 v[20:23], v7, s[16:19], s54 offen sc1
    v_mfma_f32_16x16x32_bf16 v[128:131], v[68:71], v[44:47], v[128:131]
    v_mfma_f32_16x16x32_bf16 v[148:151], v[68:71], v[48:51], v[148:151]
    s_waitcnt lgkmcnt(4)
    v_mfma_f32_16x16x32_bf16 v[92:95], v[72:75], v[36:39], v[92:95]
    ds_read_b128 v[68:71], v5 offset:16384
    v_mfma_f32_16x16x32_bf16 v[112:115], v[72:75], v[40:43], v[112:115]
    s_add_u32 s54, s65, 6144
    buffer_load_dwordx4 v[24:27], v7, s[16:19], s54 offen sc1
    v_mfma_f32_16x16x32_bf16 v[132:135], v[72:75], v[44:47], v[132:135]
    v_mfma_f32_16x16x32_bf16 v[152:155], v[72:75], v[48:51], v[152:155]
    s_waitcnt lgkmcnt(4)
    v_mfma_f32_16x16x32_bf16 v[96:99], v[76:79], v[36:39], v[96:99]
    ds_read_b128 v[72:75], v5 offset:17408
    v_mfma_f32_16x16x32_bf16 v[116:119], v[76:79], v[40:43], v[116:119]
    s_add_u32 s54, s66, 6144
    buffer_load_dwordx4 v[28:31], v7, s[16:19], s54 offen sc1
    v_mfma_f32_16x16x32_bf16 v[136:139], v[76:79], v[44:47], v[136:139]
    v_mfma_f32_16x16x32_bf16 v[156:159], v[76:79], v[48:51], v[156:159]
    s_waitcnt lgkmcnt(4)
    v_mfma_f32_16x16x32_bf16 v[100:103], v[80:83], v[36:39], v[100:103]
    ds_read_b128 v[76:79], v5 offset:40960
    v_mfma_f32_16x16x32_bf16 v[120:123], v[80:83], v[40:43], v[120:123]
    s_add_u32 s54, s67, 6144
    buffer_load_dwordx4 v[32:35], v7, s[16:19], s54 offen sc1
    v_mfma_f32_16x16x32_bf16 v[140:143], v[80:83], v[44:47], v[140:143]
    v_mfma_f32_16x16x32_bf16 v[160:163], v[80:83], v[48:51], v[160:163]
    s_waitcnt lgkmcnt(3)
    v_mfma_f32_16x16x32_bf16 v[104:107], v[84:87], v[36:39], v[104:107]
    ds_read_b128 v[80:83], v5 offset:41984
    v_mfma_f32_16x16x32_bf16 v[124:127], v[84:87], v[40:43], v[124:127]
    s_mov_b64 exec, 1
    ds_add_u32 v10, v2 offset:224
    s_mov_b64 exec, -1
    v_mfma_f32_16x16x32_bf16 v[144:147], v[84:87], v[44:47], v[144:147]
    v_mfma_f32_16x16x32_bf16 v[164:167], v[84:87], v[48:51], v[164:167]
    s_waitcnt vmcnt(4)
    s_waitcnt lgkmcnt(4)
    v_mfma_f32_16x16x32_bf16 v[88:91], v[68:71], v[52:55], v[88:91]
    ds_read_b128 v[84:87], v6 offset:8192
    v_mfma_f32_16x16x32_bf16 v[108:111], v[68:71], v[56:59], v[108:111]
    s_add_u32 s54, s64, 7168
    buffer_load_dwordx4 v[36:39], v7, s[16:19], s54 offen sc1
    v_mfma_f32_16x16x32_bf16 v[128:131], v[68:71], v[60:63], v[128:131]
    v_mfma_f32_16x16x32_bf16 v[148:151], v[68:71], v[64:67], v[148:151]
    s_waitcnt lgkmcnt(4)
    v_mfma_f32_16x16x32_bf16 v[92:95], v[72:75], v[52:55], v[92:95]
    ds_read_b128 v[68:71], v6 offset:20480
    v_mfma_f32_16x16x32_bf16 v[112:115], v[72:75], v[56:59], v[112:115]
    s_add_u32 s54, s65, 7168
    buffer_load_dwordx4 v[40:43], v7, s[16:19], s54 offen sc1
    v_mfma_f32_16x16x32_bf16 v[132:135], v[72:75], v[60:63], v[132:135]
    ds_read_b32 v11, v10 offset:160
    v_mfma_f32_16x16x32_bf16 v[152:155], v[72:75], v[64:67], v[152:155]
    s_waitcnt lgkmcnt(5)
    v_mfma_f32_16x16x32_bf16 v[96:99], v[76:79], v[52:55], v[96:99]
    ds_read_b128 v[72:75], v4 offset:32768
    v_mfma_f32_16x16x32_bf16 v[116:119], v[76:79], v[56:59], v[116:119]
    s_add_u32 s54, s66, 7168
    buffer_load_dwordx4 v[44:47], v7, s[16:19], s54 offen sc1
    v_mfma_f32_16x16x32_bf16 v[136:139], v[76:79], v[60:63], v[136:139]
    v_mfma_f32_16x16x32_bf16 v[156:159], v[76:79], v[64:67], v[156:159]
    s_waitcnt lgkmcnt(5)
    v_mfma_f32_16x16x32_bf16 v[100:103], v[80:83], v[52:55], v[100:103]
    ds_read_b128 v[76:79], v4 offset:33792
    v_mfma_f32_16x16x32_bf16 v[120:123], v[80:83], v[56:59], v[120:123]
    s_add_u32 s54, s67, 7168
    buffer_load_dwordx4 v[48:51], v7, s[16:19], s54 offen sc1
    v_mfma_f32_16x16x32_bf16 v[140:143], v[80:83], v[60:63], v[140:143]
    s_waitcnt lgkmcnt(2)
    v_readfirstlane_b32 s38, v11
    v_mfma_f32_16x16x32_bf16 v[160:163], v[80:83], v[64:67], v[160:163]
    s_waitcnt lgkmcnt(4)
    v_mfma_f32_16x16x32_bf16 v[104:107], v[84:87], v[52:55], v[104:107]
    ds_read_b128 v[80:83], v4 offset:34816
    v_mfma_f32_16x16x32_bf16 v[124:127], v[84:87], v[56:59], v[124:127]
    s_mov_b64 exec, 1
    ds_add_u32 v10, v2 offset:224
    s_mov_b64 exec, -1
    v_mfma_f32_16x16x32_bf16 v[144:147], v[84:87], v[60:63], v[144:147]
    s_cmp_ge_u32 s38, 1
    s_cbranch_scc1 k_sk_84
k_w_85:
    ds_read_b32 v3, v10 offset:160
    s_waitcnt lgkmcnt(0)
    v_readfirstlane_b32 s37, v3
    s_add_u32 s35, s35, 1
    s_cmp_ge_u32 s37, 1
    s_cbranch_scc1 k_w_85_x
    s_cmp_lt_u32 s35, 2097152
    s_cbranch_scc1 k_w_85
k_w_85_x:
k_sk_84:
    v_mfma_f32_16x16x32_bf16 v[164:167], v[84:87], v[64:67], v[164:167]
    s_waitcnt vmcnt(4)
    s_waitcnt lgkmcnt(5)
    v_mfma_f32_16x16x32_bf16 v[88:91], v[68:71], v[20:23], v[88:91]
    ds_read_b128 v[84:87], v4 offset:35840
    v_mfma_f32_16x16x32_bf16 v[108:111], v[68:71], v[24:27], v[108:111]
    s_add_u32 s54, s64, 8192
    buffer_load_dwordx4 v[52:55], v7, s[16:19], s54 offen sc1
    v_mfma_f32_16x16x32_bf16 v[128:131], v[68:71], v[28:31], v[128:131]
    v_mfma_f32_16x16x32_bf16 v[148:151], v[68:71], v[32:35], v[148:151]
    s_waitcnt lgkmcnt(4)
    v_mfma_f32_16x16x32_bf16 v[92:95], v[72:75], v[20:23], v[92:95]
    ds_read_b128 v[68:71], v5 offset:0
    v_mfma_f32_16x16x32_bf16 v[112:115], v[72:75], v[24:27], v[112:115]
    s_add_u32 s54, s65, 8192
    buffer_load_dwordx4 v[56:59], v7, s[16:19], s54 offen sc1
    v_mfma_f32_16x16x32_bf16 v[132:135], v[72:75], v[28:31], v[132:135]
    v_mfma_f32_16x16x32_bf16 v[152:155], v[72:75], v[32:35], v[152:155]
    s_waitcnt lgkmcnt(4)
    v_mfma_f32_16x16x32_bf16 v[96:99], v[76:79], v[20:23], v[96:99]
    ds_read_b128 v[72:75], v5 offset:1024
    v_mfma_f32_16x16x32_bf16 v[116:119], v[76:79], v[24:27], v[116:119]
    s_add_u32 s54, s66, 8192
    buffer_load_dwordx4 v[60:63], v7, s[16:19], s54 offen sc1
    v_mfma_f32_16x16x32_bf16 v[136:139], v[76:79], v[28:31], v[136:139]
    v_mfma_f32_16x16x32_bf16 v[156:159], v[76:79], v[32:35], v[156:159]
    s_waitcnt lgkmcnt(4)
    v_mfma_f32_16x16x32_bf16 v[100:103], v[80:83], v[20:23], v[100:103]
    ds_read_b128 v[76:79], v5 offset:24576
    v_mfma_f32_16x16x32_bf16 v[120:123], v[80:83], v[24:27], v[120:123]
    s_add_u32 s54, s67, 8192
    buffer_load_dwordx4 v[64:67], v7, s[16:19], s54 offen sc1
    v_mfma_f32_16x16x32_bf16 v[140:143], v[80:83], v[28:31], v[140:143]
    v_mfma_f32_16x16x32_bf16 v[160:163], v[80:83], v[32:35], v[160:163]
    s_waitcnt lgkmcnt(3)
    v_mfma_f32_16x16x32_bf16 v[104:107], v[84:87], v[20:23], v[104:107]
    ds_read_b128 v[80:83], v5 offset:25600
    v_mfma_f32_16x16x32_bf16 v[124:127], v[84:87], v[24:27], v[124:127]
    s_mov_b64 exec, 1
    ds_add_u32 v10, v2 offset:224
    s_mov_b64 exec, -1
    v_mfma_f32_16x16x32_bf16 v[144:147], v[84:87], v[28:31], v[144:147]
    v_mfma_f32_16x16x32_bf16 v[164:167], v[84:87], v[32:35], v[164:167]
    s_waitcnt vmcnt(4)
    s_cmp_eq_u32 s61, 2
    s_cbranch_scc1 k_h_87_x
k_h_87:
    s_load_dwordx4 s[60:63], s[82:83], s55 glc
    s_add_u32 s35, s35, 1
    s_waitcnt lgkmcnt(0)
    s_cmp_eq_u32 s61, 2
    s_cbranch_scc1 k_h_87_x
    s_cmp_lt_u32 s35, 2097152
    s_cbranch_scc1 k_h_87
k_h_87_x:
    s_waitcnt lgkmcnt(4)
    v_mfma_f32_16x16x32_bf16 v[88:91], v[68:71], v[36:39], v[88:91]
    ds_read_b128 v[84:87], v6 offset:0
    v_mfma_f32_16x16x32_bf16 v[108:111], v[68:71], v[40:43], v[108:111]
    s_add_u32 s54, s64, 3072
    buffer_load_dwordx4 v[20:23], v7, s[16:19], s54 offen sc1
    v_mfma_f32_16x16x32_bf16 v[128:131], v[68:71], v[44:47], v[128:131]
    v_mfma_f32_16x16x32_bf16 v[148:151], v[68:71], v[48:51], v[148:151]
    s_waitcnt lgkmcnt(4)
    v_mfma_f32_16x16x32_bf16 v[92:95], v[72:75], v[36:39], v[92:95]
    ds_read_b128 v[68:71], v6 offset:12288
    v_mfma_f32_16x16x32_bf16 v[112:115], v[72:75], v[40:43], v[112:115]
    s_add_u32 s54, s65, 3072
    buffer_load_dwordx4 v[24:27], v7, s[16:19], s54 offen sc1
    v_mfma_f32_16x16x32_bf16 v[132:135], v[72:75], v[44:47], v[132:135]
    ds_read_b32 v11, v10 offset:176
    v_mfma_f32_16x16x32_bf16 v[152:155], v[72:75], v[48:51], v[152:155]
    s_waitcnt lgkmcnt(5)
    v_mfma_f32_16x16x32_bf16 v[96:99], v[76:79], v[36:39], v[96:99]
    ds_read_b128 v[72:75], v4 offset:0
    v_mfma_f32_16x16x32_bf16 v[116:119], v[76:79], v[40:43], v[116:119]
    s_add_u32 s54, s66, 3072
    buffer_load_dwordx4 v[28:31], v7, s[16:19], s54 offen sc1
    v_mfma_f32_16x16x32_bf16 v[136:139], v[76:79], v[44:47], v[136:139]
    v_mfma_f32_16x16x32_bf16 v[156:159], v[76:79], v[48:51], v[156:159]
    s_waitcnt lgkmcnt(5)
    v_mfma_f32_16x16x32_bf16 v[100:103], v[80:83], v[36:39], v[100:103]
    ds_read_b128 v[76:79], v4 offset:1024
    v_mfma_f32_16x16x32_bf16 v[120:123], v[80:83], v[40:43], v[120:123]
    s_add_u32 s54, s67, 3072
    buffer_load_dwordx4 v[32:35], v7, s[16:19], s54 offen sc1
    v_mfma_f32_16x16x32_bf16 v[140:143], v[80:83], v[44:47], v[140:143]
    s_waitcnt lgkmcnt(2)
    v_readfirstlane_b32 s38, v11
    v_mfma_f32_16x16x32_bf16 v[160:163], v[80:83], v[48:51], v[160:163]
    s_waitcnt lgkmcnt(4)
    v_mfma_f32_16x16x32_bf16 v[104:107], v[84:87], v[36:39], v[104:107]
    ds_read_b128 v[80:83], v4 offset:2048
    v_mfma_f32_16x16x32_bf16 v[124:127], v[84:87], v[40:43], v[124:127]
    s_mov_b64 exec, 1
    ds_add_u32 v10, v2 offset:224
    s_mov_b64 exec, -1
    v_mfma_f32_16x16x32_bf16 v[144:147], v[84:87], v[44:47], v[144:147]
    s_cmp_ge_u32 s38, 1
    s_cbranch_scc1 k_sk_88
k_w_89:
    ds_read_b32 v3, v10 offset:176
    s_waitcnt lgkmcnt(0)
    v_readfirstlane_b32 s37, v3
    s_add_u32 s35, s35, 1
    s_cmp_ge_u32 s37, 1
    s_cbranch_scc1 k_w_89_x
    s_cmp_lt_u32 s35, 2097152
    s_cbranch_scc1 k_w_89
k_w_89_x:
k_sk_88:
    v_mfma_f32_16x16x32_bf16 v[164:167], v[84:87], v[48:51], v[164:167]
    s_waitcnt vmcnt(4)
    s_waitcnt lgkmcnt(5)
    v_mfma_f32_16x16x32_bf16 v[88:91], v[68:71], v[52:55], v[88:91]
    ds_read_b128 v[84:87], v4 offset:3072
    v_mfma_f32_16x16x32_bf16 v[108:111], v[68:71], v[56:59], v[108:111]
    s_add_u32 s54, s64, 4096
    buffer_load_dwordx4 v[36:39], v7, s[16:19], s54 offen sc1
    v_mfma_f32_16x16x32_bf16 v[128:131], v[68:71], v[60:63], v[128:131]
    v_mfma_f32_16x16x32_bf16 v[148:151], v[68:71], v[64:67], v[148:151]
    s_waitcnt lgkmcnt(4)
    v_mfma_f32_16x16x32_bf16 v[92:95], v[72:75], v[52:55], v[92:95]
    ds_read_b128 v[68:71], v5 offset:8192
    v_mfma_f32_16x16x32_bf16 v[112:115], v[72:75], v[56:59], v[112:115]
    s_add_u32 s54, s65, 4096
    buffer_load_dwordx4 v[40:43], v7, s[16:19], s54 offen sc1
    v_mfma_f32_16x16x32_bf16 v[132:135], v[72:75], v[60:63], v[132:135]
    ds_read_b32 v11, v10 offset:176
    v_mfma_f32_16x16x32_bf16 v[152:155], v[72:75], v[64:67], v[152:155]
    s_waitcnt lgkmcnt(5)
    v_mfma_f32_16x16x32_bf16 v[96:99], v[76:79], v[52:55], v[96:99]
    ds_read_b128 v[72:75], v5 offset:9216
    v_mfma_f32_16x16x32_bf16 v[116:119], v[76:79], v[56:59], v[116:119]
    s_add_u32 s54, s66, 4096
    buffer_load_dwordx4 v[44:47], v7, s[16:19], s54 offen sc1
    v_mfma_f32_16x16x32_bf16 v[136:139], v[76:79], v[60:63], v[136:139]
    v_mfma_f32_16x16x32_bf16 v[156:159], v[76:79], v[64:67], v[156:159]
    s_waitcnt lgkmcnt(5)
    v_mfma_f32_16x16x32_bf16 v[100:103], v[80:83], v[52:55], v[100:103]
    ds_read_b128 v[76:79], v5 offset:32768
    v_mfma_f32_16x16x32_bf16 v[120:123], v[80:83], v[56:59], v[120:123]
    s_add_u32 s54, s67, 4096
    buffer_load_dwordx4 v[48:51], v7, s[16:19], s54 offen sc1
    v_mfma_f32_16x16x32_bf16 v[140:143], v[80:83], v[60:63], v[140:143]
    s_waitcnt lgkmcnt(2)
    v_readfirstlane_b32 s38, v11
    v_mfma_f32_16x16x32_bf16 v[160:163], v[80:83], v[64:67], v[160:163]
    s_waitcnt lgkmcnt(4)
    v_mfma_f32_16x16x32_bf16 v[104:107], v[84:87], v[52:55], v[104:107]
    ds_read_b128 v[80:83], v5 offset:33792
    v_mfma_f32_16x16x32_bf16 v[124:127], v[84:87], v[56:59], v[124:127]
    s_mov_b64 exec, 1
    ds_add_u32 v10, v2 offset:224
    s_mov_b64 exec, -1
    v_mfma_f32_16x16x32_bf16 v[144:147], v[84:87], v[60:63], v[144:147]
    s_cmp_ge_u32 s38, 2
    s_cbranch_scc1 k_sk_90
k_w_91:
    ds_read_b32 v3, v10 offset:176
    s_waitcnt lgkmcnt(0)
    v_readfirstlane_b32 s37, v3
    s_add_u32 s35, s35, 1
    s_cmp_ge_u32 s37, 2
    s_cbranch_scc1 k_w_91_x
    s_cmp_lt_u32 s35, 2097152
    s_cbranch_scc1 k_w_91
k_w_91_x:
k_sk_90:
    v_mfma_f32_16x16x32_bf16 v[164:167], v[84:87], v[64:67], v[164:167]
    s_waitcnt vmcnt(4)
    s_waitcnt lgkmcnt(5)
    v_mfma_f32_16x16x32_bf16 v[88:91], v[68:71], v[20:23], v[88:91]
    ds_read_b128 v[84:87], v6 offset:4096
    v_mfma_f32_16x16x32_bf16 v[108:111], v[68:71], v[24:27], v[108:111]
    s_add_u32 s54, s64, 5120
    buffer_load_dwordx4 v[52:55], v7, s[16:19], s54 offen sc1
    v_mfma_f32_16x16x32_bf16 v[128:131], v[68:71], v[28:31], v[128:131]
    v_mfma_f32_16x16x32_bf16 v[148:151], v[68:71], v[32:35], v[148:151]
    s_waitcnt lgkmcnt(4)
    v_mfma_f32_16x16x32_bf16 v[92:95], v[72:75], v[20:23], v[92:95]
    ds_read_b128 v[68:71], v6 offset:16384
    v_mfma_f32_16x16x32_bf16 v[112:115], v[72:75], v[24:27], v[112:115]
    s_add_u32 s54, s65, 5120
    buffer_load_dwordx4 v[56:59], v7, s[16:19], s54 offen sc1
    v_mfma_f32_16x16x32_bf16 v[132:135], v[72:75], v[28:31], v[132:135]
    ds_read_b32 v11, v10 offset:176
    v_mfma_f32_16x16x32_bf16 v[152:155], v[72:75], v[32:35], v[152:155]
    s_waitcnt lgkmcnt(5)
    v_mfma_f32_16x16x32_bf16 v[96:99], v[76:79], v[20:23], v[96:99]
    ds_read_b128 v[72:75], v4 offset:16384
    v_mfma_f32_16x16x32_bf16 v[116:119], v[76:79], v[24:27], v[116:119]
    s_add_u32 s54, s66, 5120
    buffer_load_dwordx4 v[60:63], v7, s[16:19], s54 offen sc1
    v_mfma_f32_16x16x32_bf16 v[136:139], v[76:79], v[28:31], v[136:139]
    v_mfma_f32_16x16x32_bf16 v[156:159], v[76:79], v[32:35], v[156:159]
    s_waitcnt lgkmcnt(5)
    v_mfma_f32_16x16x32_bf16 v[100:103], v[80:83], v[20:23], v[100:103]
    ds_read_b128 v[76:79], v4 offset:17408
    v_mfma_f32_16x16x32_bf16 v[120:123], v[80:83], v[24:27], v[120:123]
    s_add_u32 s54, s67, 5120
    buffer_load_dwordx4 v[64:67], v7, s[16:19], s54 offen sc1
    v_mfma_f32_16x16x32_bf16 v[140:143], v[80:83], v[28:31], v[140:143]
    s_waitcnt lgkmcnt(2)
    v_readfirstlane_b32 s38, v11
    v_mfma_f32_16x16x32_bf16 v[160:163], v[80:83], v[32:35], v[160:163]
    s_waitcnt lgkmcnt(4)
    v_mfma_f32_16x16x32_bf16 v[104:107], v[84:87], v[20:23], v[104:107]
    ds_read_b128 v[80:83], v4 offset:18432
    v_mfma_f32_16x16x32_bf16 v[124:127], v[84:87], v[24:27], v[124:127]
    v_mfma_f32_16x16x32_bf16 v[144:147], v[84:87], v[28:31], v[144:147]
    s_cmp_ge_u32 s38, 3
    s_cbranch_scc1 k_sk_92
k_w_93:
    ds_read_b32 v3, v10 offset:176
    s_waitcnt lgkmcnt(0)
    v_readfirstlane_b32 s37, v3
    s_add_u32 s35, s35, 1
    s_cmp_ge_u32 s37, 3
    s_cbranch_scc1 k_w_93_x
    s_cmp_lt_u32 s35, 2097152
    s_cbranch_scc1 k_w_93
k_w_93_x:
k_sk_92:
    v_mfma_f32_16x16x32_bf16 v[164:167], v[84:87], v[32:35], v[164:167]
    s_waitcnt vmcnt(4)
    s_cmp_eq_u32 s60, 2
    s_cbranch_scc1 k_h_94_x
k_h_94:
    s_load_dwordx4 s[60:63], s[82:83], s55 glc
    s_add_u32 s35, s35, 1
    s_waitcnt lgkmcnt(0)
    s_cmp_eq_u32 s60, 2
    s_cbranch_scc1 k_h_94_x
    s_cmp_lt_u32 s35, 2097152
    s_cbranch_scc1 k_h_94
k_h_94_x:
    s_waitcnt lgkmcnt(4)
    v_mfma_f32_16x16x32_bf16 v[88:91], v[68:71], v[36:39], v[88:91]
    ds_read_b128 v[84:87], v4 offset:19456
    v_mfma_f32_16x16x32_bf16 v[108:111], v[68:71], v[40:43], v[108:111]
    s_add_u32 s54, s64, 0
    buffer_load_dwordx4 v[20:23], v7, s[16:19], s54 offen sc1
    v_mfma_f32_16x16x32_bf16 v[128:131], v[68:71], v[44:47], v[128:131]
    v_mfma_f32_16x16x32_bf16 v[148:151], v[68:71], v[48:51], v[148:151]
    s_waitcnt lgkmcnt(3)
    v_mfma_f32_16x16x32_bf16 v[92:95], v[72:75], v[36:39], v[92:95]
    ds_read_b128 v[68:71], v5 offset:16384
    v_mfma_f32_16x16x32_bf16 v[112:115], v[72:75], v[40:43], v[112:115]
    s_add_u32 s54, s65, 0
    buffer_load_dwordx4 v[24:27], v7, s[16:19], s54 offen sc1
    v_mfma_f32_16x16x32_bf16 v[132:135], v[72:75], v[44:47], v[132:135]
    ds_read_b32 v11, v10 offset:176
    v_mfma_f32_16x16x32_bf16 v[152:155], v[72:75], v[48:51], v[152:155]
    s_waitcnt lgkmcnt(4)
    v_mfma_f32_16x16x32_bf16 v[96:99], v[76:79], v[36:39], v[96:99]
    ds_read_b128 v[72:75], v5 offset:17408
    v_mfma_f32_16x16x32_bf16 v[116:119], v[76:79], v[40:43], v[116:119]
    s_add_u32 s54, s66, 0
    buffer_load_dwordx4 v[28:31], v7, s[16:19], s54 offen sc1
    v_mfma_f32_16x16x32_bf16 v[136:139], v[76:79], v[44:47], v[136:139]
    v_mfma_f32_16x16x32_bf16 v[156:159], v[76:79], v[48:51], v[156:159]
    s_waitcnt lgkmcnt(4)
    v_mfma_f32_16x16x32_bf16 v[100:103], v[80:83], v[36:39], v[100:103]
    ds_read_b128 v[76:79], v5 offset:40960
    v_mfma_f32_16x16x32_bf16 v[120:123], v[80:83], v[40:43], v[120:123]
    s_add_u32 s54, s67, 0
    buffer_load_dwordx4 v[32:35], v7, s[16:19], s54 offen sc1
    v_mfma_f32_16x16x32_bf16 v[140:143], v[80:83], v[44:47], v[140:143]
    s_waitcnt lgkmcnt(2)
    v_readfirstlane_b32 s38, v11
    v_mfma_f32_16x16x32_bf16 v[160:163], v[80:83], v[48:51], v[160:163]
    s_waitcnt lgkmcnt(4)
    v_mfma_f32_16x16x32_bf16 v[104:107], v[84:87], v[36:39], v[104:107]
    ds_read_b128 v[80:83], v5 offset:41984
    v_mfma_f32_16x16x32_bf16 v[124:127], v[84:87], v[40:43], v[124:127]
    v_mfma_f32_16x16x32_bf16 v[144:147], v[84:87], v[44:47], v[144:147]
    s_cmp_ge_u32 s38, 4
    s_cbranch_scc1 k_sk_95
k_w_96:
    ds_read_b32 v3, v10 offset:176
    s_waitcnt lgkmcnt(0)
    v_readfirstlane_b32 s37, v3
    s_add_u32 s35, s35, 1
    s_cmp_ge_u32 s37, 4
    s_cbranch_scc1 k_w_96_x
    s_cmp_lt_u32 s35, 2097152
    s_cbranch_scc1 k_w_96
k_w_96_x:
k_sk_95:
    v_mfma_f32_16x16x32_bf16 v[164:167], v[84:87], v[48:51], v[164:167]
    s_waitcnt vmcnt(4)
    s_waitcnt lgkmcnt(4)
    v_mfma_f32_16x16x32_bf16 v[88:91], v[68:71], v[52:55], v[88:91]
    ds_read_b128 v[84:87], v6 offset:8192
    v_mfma_f32_16x16x32_bf16 v[108:111], v[68:71], v[56:59], v[108:111]
    s_add_u32 s54, s64, 1024
    buffer_load_dwordx4 v[36:39], v7, s[16:19], s54 offen sc1
    v_mfma_f32_16x16x32_bf16 v[128:131], v[68:71], v[60:63], v[128:131]
    v_mfma_f32_16x16x32_bf16 v[148:151], v[68:71], v[64:67], v[148:151]
    s_waitcnt lgkmcnt(3)
    v_mfma_f32_16x16x32_bf16 v[92:95], v[72:75], v[52:55], v[92:95]
    ds_read_b128 v[68:71], v6 offset:20480
    v_mfma_f32_16x16x32_bf16 v[112:115], v[72:75], v[56:59], v[112:115]
    s_add_u32 s54, s65, 1024
    buffer_load_dwordx4 v[40:43], v7, s[16:19], s54 offen sc1
    v_mfma_f32_16x16x32_bf16 v[132:135], v[72:75], v[60:63], v[132:135]
    ds_read_b32 v11, v10 offset:176
    v_mfma_f32_16x16x32_bf16 v[152:155], v[72:75], v[64:67], v[152:155]
    s_waitcnt lgkmcnt(4)
    v_mfma_f32_16x16x32_bf16 v[96:99], v[76:79], v[52:55], v[96:99]
    ds_read_b128 v[72:75], v4 offset:32768
    v_mfma_f32_16x16x32_bf16 v[116:119], v[76:79], v[56:59], v[116:119]
    s_add_u32 s54, s66, 1024
    buffer_load_dwordx4 v[44:47], v7, s[16:19], s54 offen sc1
    v_mfma_f32_16x16x32_bf16 v[136:139], v[76:79], v[60:63], v[136:139]
    v_mfma_f32_16x16x32_bf16 v[156:159], v[76:79], v[64:67], v[156:159]
    s_waitcnt lgkmcnt(4)
    v_mfma_f32_16x16x32_bf16 v[100:103], v[80:83], v[52:55], v[100:103]
    ds_read_b128 v[76:79], v4 offset:33792
    v_mfma_f32_16x16x32_bf16 v[120:123], v[80:83], v[56:59], v[120:123]
    s_add_u32 s54, s67, 1024
    buffer_load_dwordx4 v[48:51], v7, s[16:19], s54 offen sc1
    v_mfma_f32_16x16x32_bf16 v[140:143], v[80:83], v[60:63], v[140:143]
    s_waitcnt lgkmcnt(2)
    v_readfirstlane_b32 s38, v11
    v_mfma_f32_16x16x32_bf16 v[160:163], v[80:83], v[64:67], v[160:163]
    s_waitcnt lgkmcnt(4)
    v_mfma_f32_16x16x32_bf16 v[104:107], v[84:87], v[52:55], v[104:107]
    ds_read_b128 v[80:83], v4 offset:34816
    v_mfma_f32_16x16x32_bf16 v[124:127], v[84:87], v[56:59], v[124:127]
    v_mfma_f32_16x16x32_bf16 v[144:147], v[84:87], v[60:63], v[144:147]
    s_cmp_ge_u32 s38, 5
    s_cbranch_scc1 k_sk_97
k_w_98:
    ds_read_b32 v3, v10 offset:176
    s_waitcnt lgkmcnt(0)
    v_readfirstlane_b32 s37, v3
    s_add_u32 s35, s35, 1
    s_cmp_ge_u32 s37, 5
    s_cbranch_scc1 k_w_98_x
    s_cmp_lt_u32 s35, 2097152
    s_cbranch_scc1 k_w_98
k_w_98_x:
k_sk_97:
    v_mfma_f32_16x16x32_bf16 v[164:167], v[84:87], v[64:67], v[164:167]
    s_waitcnt vmcnt(4)
    s_waitcnt lgkmcnt(4)
    v_mfma_f32_16x16x32_bf16 v[88:91], v[68:71], v[20:23], v[88:91]
    ds_read_b128 v[84:87], v4 offset:35840
    v_mfma_f32_16x16x32_bf16 v[108:111], v[68:71], v[24:27], v[108:111]
    s_add_u32 s54, s64, 2048
    buffer_load_dwordx4 v[52:55], v7, s[16:19], s54 offen sc1
    v_mfma_f32_16x16x32_bf16 v[128:131], v[68:71], v[28:31], v[128:131]
    v_mfma_f32_16x16x32_bf16 v[148:151], v[68:71], v[32:35], v[148:151]
    s_waitcnt lgkmcnt(3)
    v_mfma_f32_16x16x32_bf16 v[92:95], v[72:75], v[20:23], v[92:95]
    ds_read_b128 v[68:71], v5 offset:0
    v_mfma_f32_16x16x32_bf16 v[112:115], v[72:75], v[24:27], v[112:115]
    s_add_u32 s54, s65, 2048
    buffer_load_dwordx4 v[56:59], v7, s[16:19], s54 offen sc1
    v_mfma_f32_16x16x32_bf16 v[132:135], v[72:75], v[28:31], v[132:135]
    ds_read_b32 v11, v10 offset:176
    v_mfma_f32_16x16x32_bf16 v[152:155], v[72:75], v[32:35], v[152:155]
    s_waitcnt lgkmcnt(4)
    v_mfma_f32_16x16x32_bf16 v[96:99], v[76:79], v[20:23], v[96:99]
    ds_read_b128 v[72:75], v5 offset:1024
    v_mfma_f32_16x16x32_bf16 v[116:119], v[76:79], v[24:27], v[116:119]
    s_add_u32 s54, s66, 2048
    buffer_load_dwordx4 v[60:63], v7, s[16:19], s54 offen sc1
    v_mfma_f32_16x16x32_bf16 v[136:139], v[76:79], v[28:31], v[136:139]
    v_mfma_f32_16x16x32_bf16 v[156:159], v[76:79], v[32:35], v[156:159]
    s_waitcnt lgkmcnt(4)
    v_mfma_f32_16x16x32_bf16 v[100:103], v[80:83], v[20:23], v[100:103]
    ds_read_b128 v[76:79], v5 offset:24576
    v_mfma_f32_16x16x32_bf16 v[120:123], v[80:83], v[24:27], v[120:123]
    s_add_u32 s54, s67, 2048
    buffer_load_dwordx4 v[64:67], v7, s[16:19], s54 offen sc1
    v_mfma_f32_16x16x32_bf16 v[140:143], v[80:83], v[28:31], v[140:143]
    s_waitcnt lgkmcnt(2)
    v_readfirstlane_b32 s38, v11
    v_mfma_f32_16x16x32_bf16 v[160:163], v[80:83], v[32:35], v[160:163]
    s_waitcnt lgkmcnt(4)
    v_mfma_f32_16x16x32_bf16 v[104:107], v[84:87], v[20:23], v[104:107]
    ds_read_b128 v[80:83], v5 offset:25600
    v_mfma_f32_16x16x32_bf16 v[124:127], v[84:87], v[24:27], v[124:127]
    v_mfma_f32_16x16x32_bf16 v[144:147], v[84:87], v[28:31], v[144:147]
    s_cmp_ge_u32 s38, 6
    s_cbranch_scc1 k_sk_99
k_w_100:
    ds_read_b32 v3, v10 offset:176
    s_waitcnt lgkmcnt(0)
    v_readfirstlane_b32 s37, v3
    s_add_u32 s35, s35, 1
    s_cmp_ge_u32 s37, 6
    s_cbranch_scc1 k_w_100_x
    s_cmp_lt_u32 s35, 2097152
    s_cbranch_scc1 k_w_100
k_w_100_x:
k_sk_99:
    v_mfma_f32_16x16x32_bf16 v[164:167], v[84:87], v[32:35], v[164:167]
    s_waitcnt vmcnt(4)
    s_waitcnt lgkmcnt(4)
    v_mfma_f32_16x16x32_bf16 v[88:91], v[68:71], v[36:39], v[88:91]
    ds_read_b128 v[84:87], v6 offset:0
    v_mfma_f32_16x16x32_bf16 v[108:111], v[68:71], v[40:43], v[108:111]
    v_mfma_f32_16x16x32_bf16 v[128:131], v[68:71], v[44:47], v[128:131]
    v_mfma_f32_16x16x32_bf16 v[148:151], v[68:71], v[48:51], v[148:151]
    s_waitcnt lgkmcnt(3)
    v_mfma_f32_16x16x32_bf16 v[92:95], v[72:75], v[36:39], v[92:95]
    ds_read_b128 v[68:71], v6 offset:12288
    v_mfma_f32_16x16x32_bf16 v[112:115], v[72:75], v[40:43], v[112:115]
    v_mfma_f32_16x16x32_bf16 v[132:135], v[72:75], v[44:47], v[132:135]
    v_mfma_f32_16x16x32_bf16 v[152:155], v[72:75], v[48:51], v[152:155]
    s_waitcnt lgkmcnt(3)
    v_mfma_f32_16x16x32_bf16 v[96:99], v[76:79], v[36:39], v[96:99]
    ds_read_b128 v[72:75], v4 offset:0
    v_mfma_f32_16x16x32_bf16 v[116:119], v[76:79], v[40:43], v[116:119]
    v_mfma_f32_16x16x32_bf16 v[136:139], v[76:79], v[44:47], v[136:139]
    ds_read_b32 v9, v1 offset:284
    v_mfma_f32_16x16x32_bf16 v[156:159], v[76:79], v[48:51], v[156:159]
    s_waitcnt lgkmcnt(4)
    v_mfma_f32_16x16x32_bf16 v[100:103], v[80:83], v[36:39], v[100:103]
    ds_read_b128 v[76:79], v4 offset:1024
    v_mfma_f32_16x16x32_bf16 v[120:123], v[80:83], v[40:43], v[120:123]
    v_mfma_f32_16x16x32_bf16 v[140:143], v[80:83], v[44:47], v[140:143]
    v_mfma_f32_16x16x32_bf16 v[160:163], v[80:83], v[48:51], v[160:163]
    s_waitcnt lgkmcnt(4)
    v_mfma_f32_16x16x32_bf16 v[104:107], v[84:87], v[36:39], v[104:107]
    ds_read_b128 v[80:83], v4 offset:2048
    v_mfma_f32_16x16x32_bf16 v[124:127], v[84:87], v[40:43], v[124:127]
    v_mfma_f32_16x16x32_bf16 v[144:147], v[84:87], v[44:47], v[144:147]
    v_mfma_f32_16x16x32_bf16 v[164:167], v[84:87], v[48:51], v[164:167]
    ds_read_b128 v[84:87], v4 offset:3072
    s_waitcnt vmcnt(0)
    s_waitcnt lgkmcnt(3)
    v_readfirstlane_b32 s58, v9
    s_cmp_eq_u32 s58, 0
    s_cbranch_scc1 k_xalate
    buffer_load_dwordx4 v[20:23], v15, s[16:19], s57 offen sc1
    buffer_load_dwordx4 v[24:27], v15, s[16:19], s57 offen offset:64 sc1
    buffer_load_dwordx2 v[28:29], v16, s[16:19], s57 offen offset:128 sc1
k_xalate:
    s_waitcnt lgkmcnt(0)
    v_mfma_f32_16x16x32_bf16 v[108:111], v[68:71], v[56:59], v[108:111]
    v_mfma_f32_16x16x32_bf16 v[112:115], v[72:75], v[56:59], v[112:115]
    v_mfma_f32_16x16x32_bf16 v[116:119], v[76:79], v[56:59], v[116:119]
    v_mfma_f32_16x16x32_bf16 v[120:123], v[80:83], v[56:59], v[120:123]
    v_mfma_f32_16x16x32_bf16 v[124:127], v[84:87], v[56:59], v[124:127]
    v_mfma_f32_16x16x32_bf16 v[128:131], v[68:71], v[60:63], v[128:131]
    s_nop 2
    ds_write_b128 v4, v[108:111] offset:0
    v_mfma_f32_16x16x32_bf16 v[132:135], v[72:75], v[60:63], v[132:135]
    ds_write_b128 v4, v[112:115] offset:1024
    v_mfma_f32_16x16x32_bf16 v[136:139], v[76:79], v[60:63], v[136:139]
    ds_write_b128 v4, v[116:119] offset:2048
    v_mfma_f32_16x16x32_bf16 v[140:143], v[80:83], v[60:63], v[140:143]
    ds_write_b128 v4, v[120:123] offset:3072
    v_mfma_f32_16x16x32_bf16 v[144:147], v[84:87], v[60:63], v[144:147]
    ds_write_b128 v4, v[124:127] offset:16384
    v_mfma_f32_16x16x32_bf16 v[148:151], v[68:71], v[64:67], v[148:151]
    ds_write_b128 v4, v[128:131] offset:17408
    v_mfma_f32_16x16x32_bf16 v[152:155], v[72:75], v[64:67], v[152:155]
    ds_write_b128 v4, v[132:135] offset:18432
    v_mfma_f32_16x16x32_bf16 v[156:159], v[76:79], v[64:67], v[156:159]
    ds_write_b128 v4, v[136:139] offset:19456
    v_mfma_f32_16x16x32_bf16 v[160:163], v[80:83], v[64:67], v[160:163]
    ds_write_b128 v4, v[140:143] offset:32768
    v_mfma_f32_16x16x32_bf16 v[164:167], v[84:87], v[64:67], v[164:167]
    ds_write_b128 v4, v[144:147] offset:33792
    v_mfma_f32_16x16x32_bf16 v[88:91], v[68:71], v[52:55], v[88:91]
    ds_write_b128 v4, v[148:151] offset:34816
    v_mfma_f32_16x16x32_bf16 v[92:95], v[72:75], v[52:55], v[92:95]
    ds_write_b128 v4, v[152:155] offset:35840
    v_mfma_f32_16x16x32_bf16 v[96:99], v[76:79], v[52:55], v[96:99]
    ds_write_b128 v5, v[156:159] offset:0
    v_mfma_f32_16x16x32_bf16 v[100:103], v[80:83], v[52:55], v[100:103]
    ds_write_b128 v5, v[160:163] offset:8192
    v_mfma_f32_16x16x32_bf16 v[104:107], v[84:87], v[52:55], v[104:107]
    ds_write_b128 v5, v[164:167] offset:16384
    s_setprio 3
    s_mov_b64 exec, 1
    ds_add_u32 v1, v2 offset:276
    s_mov_b64 exec, -1
    s_cmp_lg_u32 s58, 0
    s_cbranch_scc1 k_xaok
k_w_102:
    ds_read_b32 v3, v1 offset:284
    s_waitcnt lgkmcnt(0)
    v_readfirstlane_b32 s37, v3
    s_add_u32 s35, s35, 1
    s_cmp_eq_u32 s37, 1
    s_cbranch_scc1 k_w_102_x
    s_sleep 1
    s_cmp_lt_u32 s35, 2097152
    s_cbranch_scc1 k_w_102
k_w_102_x:
    buffer_load_dwordx4 v[20:23], v15, s[16:19], s57 offen sc1
    buffer_load_dwordx4 v[24:27], v15, s[16:19], s57 offen offset:64 sc1
    buffer_load_dwordx2 v[28:29], v16, s[16:19], s57 offen offset:128 sc1
k_xaok:
k_x_103:
    ds_read_b32 v3, v1 offset:276
    ds_read_b128 v[108:111], v17 offset:0
    ds_read_b128 v[112:115], v17 offset:1024
    ds_read_b128 v[116:119], v17 offset:2048
    ds_read_b128 v[120:123], v17 offset:3072
    ds_read_b128 v[124:127], v17 offset:16384
    ds_read_b128 v[128:131], v18 offset:17408
    ds_read_b128 v[132:135], v18 offset:18432
    ds_read_b128 v[136:139], v18 offset:19456
    ds_read_b128 v[140:143], v18 offset:32768
    ds_read_b128 v[144:147], v18 offset:33792
    ds_read_b128 v[148:151], v19 offset:34816
    ds_read_b128 v[152:155], v19 offset:35840
    ds_read_b128 v[156:159], v8 offset:0
    ds_read_b128 v[160:163], v8 offset:8192
    ds_read_b128 v[164:167], v8 offset:16384
    s_add_u32 s35, s35, 1
    s_waitcnt lgkmcnt(15)
    v_readfirstlane_b32 s37, v3
    s_cmp_eq_u32 s37, 4
    s_cbranch_scc1 k_x_103_x
    s_cmp_lt_u32 s35, 2097152
    s_cbranch_scc1 k_x_103
k_x_103_x:
    s_waitcnt lgkmcnt(14)
    v_add_f32 v88, v88, v108
    v_add_f32 v89, v89, v109
    v_add_f32 v90, v90, v110
    v_add_f32 v91, v91, v111
    s_waitcnt lgkmcnt(13)
    v_add_f32 v92, v92, v112
    v_add_f32 v93, v93, v113
    v_add_f32 v94, v94, v114
    v_add_f32 v95, v95, v115
    s_waitcnt lgkmcnt(12)
    v_add_f32 v96, v96, v116
    v_add_f32 v97, v97, v117
    v_add_f32 v98, v98, v118
    v_add_f32 v99, v99, v119
    s_waitcnt lgkmcnt(11)
    v_add_f32 v100, v100, v120
    v_add_f32 v101, v101, v121
    v_add_f32 v102, v102, v122
    v_add_f32 v103, v103, v123
    s_waitcnt lgkmcnt(10)
    v_add_f32 v104, v104, v124
    v_add_f32 v105, v105, v125
    v_add_f32 v106, v106, v126
    v_add_f32 v107, v107, v127
    s_waitcnt lgkmcnt(9)
    v_add_f32 v88, v88, v128
    v_add_f32 v89, v89, v129
    v_add_f32 v90, v90, v130
    v_add_f32 v91, v91, v131
    s_waitcnt lgkmcnt(8)
    v_add_f32 v92, v92, v132
    v_add_f32 v93, v93, v133
    v_add_f32 v94, v94, v134
    v_add_f32 v95, v95, v135
    s_waitcnt lgkmcnt(7)
    v_add_f32 v96, v96, v136
    v_add_f32 v97, v97, v137
    v_add_f32 v98, v98, v138
    v_add_f32 v99, v99, v139
    s_waitcnt lgkmcnt(6)
    v_add_f32 v100, v100, v140
    v_add_f32 v101, v101, v141
    v_add_f32 v102, v102, v142
    v_add_f32 v103, v103, v143
    s_waitcnt lgkmcnt(5)
    v_add_f32 v104, v104, v144
    v_add_f32 v105, v105, v145
    v_add_f32 v106, v106, v146
    v_add_f32 v107, v107, v147
    s_waitcnt lgkmcnt(4)
    v_add_f32 v88, v88, v148
    v_add_f32 v89, v89, v149
    v_add_f32 v90, v90, v150
    v_add_f32 v91, v91, v151
    s_waitcnt lgkmcnt(3)
    v_add_f32 v92, v92, v152
    v_add_f32 v93, v93, v153
    v_add_f32 v94, v94, v154
    v_add_f32 v95, v95, v155
    s_waitcnt lgkmcnt(2)
    v_add_f32 v96, v96, v156
    v_add_f32 v97, v97, v157
    v_add_f32 v98, v98, v158
    v_add_f32 v99, v99, v159
    s_waitcnt lgkmcnt(1)
    v_add_f32 v100, v100, v160
    v_add_f32 v101, v101, v161
    v_add_f32 v102, v102, v162
    v_add_f32 v103, v103, v163
    s_waitcnt lgkmcnt(0)
    v_add_f32 v104, v104, v164
    v_add_f32 v105, v105, v165
    v_add_f32 v106, v106, v166
    v_add_f32 v107, v107, v167
    s_waitcnt vmcnt(0)
    v_lshlrev_b32 v32, 16, v20
    v_and_b32 v33, 0xffff0000, v20
    v_add_f32 v32, v32, v88
    v_add_f32 v33, v33, v89
    v_cvt_pk_bf16_f32 v34, v32, v33
    v_lshlrev_b32 v32, 16, v21
    v_and_b32 v33, 0xffff0000, v21
    v_add_f32 v32, v32, v90
    v_add_f32 v33, v33, v91
    v_cvt_pk_bf16_f32 v35, v32, v33
    v_lshlrev_b32 v32, 16, v22
    v_and_b32 v33, 0xffff0000, v22
    v_add_f32 v32, v32, v92
    v_add_f32 v33, v33, v93
    v_cvt_pk_bf16_f32 v36, v32, v33
    v_lshlrev_b32 v32, 16, v23
    v_and_b32 v33, 0xffff0000, v23
    v_add_f32 v32, v32, v94
    v_add_f32 v33, v33, v95
    v_cvt_pk_bf16_f32 v37, v32, v33
    v_lshlrev_b32 v32, 16, v24
    v_and_b32 v33, 0xffff0000, v24
    v_add_f32 v32, v32, v96
    v_add_f32 v33, v33, v97
    v_cvt_pk_bf16_f32 v38, v32, v33
    v_lshlrev_b32 v32, 16, v25
    v_and_b32 v33, 0xffff0000, v25
    v_add_f32 v32, v32, v98
    v_add_f32 v33, v33, v99
    v_cvt_pk_bf16_f32 v39, v32, v33
    v_lshlrev_b32 v32, 16, v26
    v_and_b32 v33, 0xffff0000, v26
    v_add_f32 v32, v32, v100
    v_add_f32 v33, v33, v101
    v_cvt_pk_bf16_f32 v40, v32, v33
    v_lshlrev_b32 v32, 16, v27
    v_and_b32 v33, 0xffff0000, v27
    v_add_f32 v32, v32, v102
    v_add_f32 v33, v33, v103
    v_cvt_pk_bf16_f32 v41, v32, v33
    v_lshlrev_b32 v32, 16, v28
    v_and_b32 v33, 0xffff0000, v28
    v_add_f32 v32, v32, v104
    v_add_f32 v33, v33, v105
    v_cvt_pk_bf16_f32 v42, v32, v33
    v_lshlrev_b32 v32, 16, v29
    v_and_b32 v33, 0xffff0000, v29
    v_add_f32 v32, v32, v106
    v_add_f32 v33, v33, v107
    v_cvt_pk_bf16_f32 v43, v32, v33
    buffer_store_dwordx4 v[34:37], v15, s[20:23], s56 offen
    buffer_store_dwordx4 v[38:41], v15, s[20:23], s56 offen offset:64
    buffer_store_dwordx2 v[42:43], v16, s[20:23], s56 offen offset:128
k_fin:
k_end:
    s_endpgm
k_tend:
.fill 64, 4, 0xbf800000
.section .rodata,"a"
.p2align 6
.amdhsa_kernel parallel_sum__spectral_gfnet__glu_gated_swiglu__prompt_kernel
  .amdhsa_next_free_vgpr 168
  .amdhsa_next_free_sgpr 102
  .amdhsa_accum_offset 168
  .amdhsa_group_segment_fixed_size 0
  .amdhsa_kernarg_size 80
  .amdhsa_user_sgpr_count 2
  .amdhsa_user_sgpr_kernarg_segment_ptr 1
  .amdhsa_system_sgpr_workgroup_id_x 1
.end_amdhsa_kernel
```
